```python
import torch

def _softmax(x, axis=-1):
    return torch.softmax(x, dim=axis)
def _gelu(x):
    return torch.nn.functional.gelu(x, approximate="tanh")
def _silu(x):
    return torch.nn.functional.silu(x)
def _sigmoid(x):
    return torch.sigmoid(x)
def _layernorm(x, axis=-1, eps=1e-5):
    m = x.mean(dim=axis, keepdim=True)
    v = x.var(dim=axis, keepdim=True, unbiased=False)
    return (x - m) / torch.sqrt(v + eps)
def _scatter_add(tgt, idx, src, axis=0):
    return tgt.clone().index_add_(axis, idx, src)
def _segment_sum(src, seg, n):
    out = torch.zeros((n,) + src.shape[1:], dtype=src.dtype)
    return out.index_add_(0, seg, src)
def _pad(x, pw):
    flat = tuple(v for pair in reversed(pw) for v in pair)
    return torch.nn.functional.pad(x, flat)

kernel_name = 'standalone__mha_block_cached__near_ridge'

def setup_inputs():

    _w = (lambda a: (lambda t: t.to(torch.bfloat16) if t.is_floating_point() else t)(torch.as_tensor(a)))
    B, Sq, D = 8, 128, 576
    H, Sk, Dh = 32, 512, 128
    return {
        "x": _w((lambda *s: torch.randn(*s, dtype=torch.bfloat16) * 0.8)(B, Sq, D)),
        "k_cache": _w((lambda *s: torch.randn(*s, dtype=torch.bfloat16) * 0.8)(B, H, Sk, Dh)),
        "v_cache": _w((lambda *s: torch.randn(*s, dtype=torch.bfloat16) * 0.05)(B, H, Sk, Dh)),
        "wq": _w((lambda *s: torch.randn(*s, dtype=torch.bfloat16) * 0.8)(D, H * Dh) * (D ** -0.5)),
        "wo": _w((lambda *s: torch.randn(*s, dtype=torch.bfloat16) * 0.05)(H * Dh, D) * ((H * Dh) ** -0.5)),
    }

def reference(x, k_cache, v_cache, wq, wo):
    B, Sq, D = x.shape
    H, Dh = 32, 128
    q = (lambda x, *d: x.permute(*d))((x @ wq).reshape(B, Sq, H, Dh), 0, 2, 1, 3)
    scores = torch.einsum("bhqd,bhkd->bhqk", q, k_cache) * (Dh ** -0.5)
    p = _softmax(scores, axis=-1)
    o = torch.einsum("bhqk,bhkd->bhqd", p, v_cache)
    return (lambda x, *d: x.permute(*d))(o, 0, 2, 1, 3).reshape(B, Sq, H * Dh) @ wo
```

```asm
; @launch grid=(256,1,1) block=(512,1,1) lds=163840
.amdgcn_target "amdgcn-amd-amdhsa--gfx950"
.text
.globl standalone__mha_block_cached__near_ridge_kernel
.p2align 8
.type standalone__mha_block_cached__near_ridge_kernel,@function
standalone__mha_block_cached__near_ridge_kernel:
    s_cmp_ge_u32 s2, 256
    s_cbranch_scc1 L_done
    s_load_dwordx16 s[4:19], s[0:1], 0
    v_and_b32 v1, 63, v0
    v_lshrrev_b32 v2, 6, v0
    s_and_b32 s21, s2, 7
    v_readfirstlane_b32 s68, v2
    s_lshr_b32 s65, s2, 3
    s_and_b32 s22, s65, 3
    s_lshr_b32 s23, s65, 2
    s_lshl_b32 s24, s21, 2
    s_add_u32 s24, s24, s22
    s_and_b32 s20, s68, 3
    s_lshl_b32 s74, s20, 12
    s_cmp_lt_u32 s68, 4
    s_cbranch_scc1 L_compute
    s_add_u32 s66, s23, s22
    s_cmp_ge_u32 s66, 9
    s_cselect_b32 s65, 9, 0
    s_sub_u32 s66, s66, s65
    s_mul_i32 s69, s20, 36864
    s_lshl_b32 s71, s20, 17
    s_lshl_b32 s63, s66, 7
    s_add_u32 s63, s63, s69
    s_lshl_b32 s64, s66, 19
    s_add_u32 s64, s64, s71
    s_add_u32 s25, s69, 1152
    v_lshrrev_b32 v2, 4, v1
    v_and_b32 v3, 15, v1
    v_lshrrev_b32 v4, 3, v1
    v_and_b32 v5, 7, v1
    v_mul_u32_u24 v7, 1152, v4
    v_xor_b32 v6, v2, v5
    v_lshlrev_b32 v6, 4, v6
    v_add_u32 v10, v6, v7
    v_add_u32 v12, 16384, v10
    v_xor_b32 v6, 64, v6
    v_add_u32 v6, v6, v7
    v_add_u32 v11, 8192, v6
    v_add_u32 v13, 24576, v6
    v_lshlrev_b32 v8, 2, v2
    v_xor_b32 v8, v8, v3
    v_lshlrev_b32 v8, 4, v8
    v_lshlrev_b32 v7, 13, v2
    v_add_u32 v14, v7, v8
    v_add_u32 v15, 31744, v14
    v_add_u32 v16, 63488, v14
    v_add_u32 v17, 95232, v14
    s_waitcnt lgkmcnt(0)
    s_mul_i32 s65, s23, 147456
    s_add_u32 s28, s4, s65
    s_addc_u32 s29, s5, 0
    s_mov_b32 s30, 147456
    s_mov_b32 s31, 0x20000
    s_lshl_b32 s65, s24, 8
    s_add_u32 s32, s10, s65
    s_addc_u32 s33, s11, 0
    s_sub_u32 s34, 4718592, s65
    s_mov_b32 s35, 0x20000
    s_add_u32 m0, s74, 32768
    s_nop 0
    buffer_load_dwordx4 v10, s[28:31], s63 offen offset:0 lds
    buffer_load_dwordx4 v11, s[28:31], s63 offen offset:1024 lds
    buffer_load_dwordx4 v12, s[28:31], s63 offen offset:2048 lds
    buffer_load_dwordx4 v13, s[28:31], s63 offen offset:3072 lds
    s_add_u32 m0, s74, 49152
    s_nop 0
    buffer_load_dwordx4 v14, s[32:35], s64 offen offset:0 lds
    buffer_load_dwordx4 v15, s[32:35], s64 offen offset:1024 lds
    buffer_load_dwordx4 v16, s[32:35], s64 offen offset:2048 lds
    buffer_load_dwordx4 v17, s[32:35], s64 offen offset:3072 lds
    s_add_u32 s63, s63, 128
    s_add_u32 s64, s64, 524288
    s_cmp_eq_u32 s63, s25
    s_cselect_b32 s63, s69, s63
    s_cselect_b32 s64, s71, s64
    s_add_u32 m0, s74, 65536
    s_nop 0
    buffer_load_dwordx4 v10, s[28:31], s63 offen offset:0 lds
    buffer_load_dwordx4 v11, s[28:31], s63 offen offset:1024 lds
    buffer_load_dwordx4 v12, s[28:31], s63 offen offset:2048 lds
    buffer_load_dwordx4 v13, s[28:31], s63 offen offset:3072 lds
    s_add_u32 m0, s74, 81920
    s_nop 0
    buffer_load_dwordx4 v14, s[32:35], s64 offen offset:0 lds
    buffer_load_dwordx4 v15, s[32:35], s64 offen offset:1024 lds
    buffer_load_dwordx4 v16, s[32:35], s64 offen offset:2048 lds
    buffer_load_dwordx4 v17, s[32:35], s64 offen offset:3072 lds
    s_add_u32 s63, s63, 128
    s_add_u32 s64, s64, 524288
    s_cmp_eq_u32 s63, s25
    s_cselect_b32 s63, s69, s63
    s_cselect_b32 s64, s71, s64
    s_waitcnt vmcnt(12)
    s_waitcnt vmcnt(8)
    s_barrier
    s_add_u32 m0, s74, 0
    s_nop 0
    buffer_load_dwordx4 v10, s[28:31], s63 offen offset:0 lds
    buffer_load_dwordx4 v11, s[28:31], s63 offen offset:1024 lds
    buffer_load_dwordx4 v12, s[28:31], s63 offen offset:2048 lds
    buffer_load_dwordx4 v13, s[28:31], s63 offen offset:3072 lds
    s_add_u32 m0, s74, 16384
    s_nop 0
    buffer_load_dwordx4 v14, s[32:35], s64 offen offset:0 lds
    buffer_load_dwordx4 v15, s[32:35], s64 offen offset:1024 lds
    buffer_load_dwordx4 v16, s[32:35], s64 offen offset:2048 lds
    buffer_load_dwordx4 v17, s[32:35], s64 offen offset:3072 lds
    s_add_u32 s63, s63, 128
    s_add_u32 s64, s64, 524288
    s_cmp_eq_u32 s63, s25
    s_cselect_b32 s63, s69, s63
    s_cselect_b32 s64, s71, s64
    s_add_u32 s76, s23, s24
    v_lshlrev_b32 v7, 8, v2
    v_add_u32 v22, v7, v8
    v_add_u32 v6, 0, v2
    v_xor_b32 v6, v6, v3
    v_lshlrev_b32 v6, 4, v6
    v_add_u32 v18, v6, v7
    v_add_u32 v6, 4, v2
    v_xor_b32 v6, v6, v3
    v_lshlrev_b32 v6, 4, v6
    v_add_u32 v19, v6, v7
    v_add_u32 v6, 8, v2
    v_xor_b32 v6, v6, v3
    v_lshlrev_b32 v6, 4, v6
    v_add_u32 v20, v6, v7
    v_add_u32 v6, 12, v2
    v_xor_b32 v6, v6, v3
    v_lshlrev_b32 v6, 4, v6
    v_add_u32 v21, v6, v7
    s_lshl_b32 s65, s23, 5
    s_add_u32 s65, s65, s24
    s_lshl_b32 s65, s65, 17
    s_add_u32 s36, s6, s65
    s_addc_u32 s37, s7, 0
    s_mov_b32 s38, 131072
    s_mov_b32 s39, 0x20000
    s_add_u32 s40, s8, s65
    s_addc_u32 s41, s9, 0
    s_mov_b32 s42, 131072
    s_mov_b32 s43, 0x20000
    s_waitcnt vmcnt(12)
    s_waitcnt vmcnt(8)
    s_barrier
    s_add_u32 m0, s74, 32768
    s_nop 0
    buffer_load_dwordx4 v10, s[28:31], s63 offen offset:0 lds
    buffer_load_dwordx4 v11, s[28:31], s63 offen offset:1024 lds
    buffer_load_dwordx4 v12, s[28:31], s63 offen offset:2048 lds
    buffer_load_dwordx4 v13, s[28:31], s63 offen offset:3072 lds
    s_add_u32 m0, s74, 49152
    s_nop 0
    buffer_load_dwordx4 v14, s[32:35], s64 offen offset:0 lds
    buffer_load_dwordx4 v15, s[32:35], s64 offen offset:1024 lds
    buffer_load_dwordx4 v16, s[32:35], s64 offen offset:2048 lds
    buffer_load_dwordx4 v17, s[32:35], s64 offen offset:3072 lds
    s_add_u32 s63, s63, 128
    s_add_u32 s64, s64, 524288
    s_cmp_eq_u32 s63, s25
    s_cselect_b32 s63, s69, s63
    s_cselect_b32 s64, s71, s64
    s_add_u32 m0, s74, 98304
    s_add_u32 s75, s76, 0
    s_and_b32 s75, s75, 7
    s_lshl_b32 s75, s75, 14
    s_add_u32 s75, s75, s74
    buffer_load_dwordx4 v18, s[36:39], s75 offen offset:0 nt lds
    buffer_load_dwordx4 v19, s[36:39], s75 offen offset:1024 nt lds
    buffer_load_dwordx4 v20, s[36:39], s75 offen offset:2048 nt lds
    buffer_load_dwordx4 v21, s[36:39], s75 offen offset:3072 nt lds
    s_waitcnt vmcnt(16)
    s_waitcnt vmcnt(12)
    s_barrier
    s_add_u32 m0, s74, 65536
    s_nop 0
    buffer_load_dwordx4 v10, s[28:31], s63 offen offset:0 lds
    buffer_load_dwordx4 v11, s[28:31], s63 offen offset:1024 lds
    buffer_load_dwordx4 v12, s[28:31], s63 offen offset:2048 lds
    buffer_load_dwordx4 v13, s[28:31], s63 offen offset:3072 lds
    s_add_u32 m0, s74, 81920
    s_nop 0
    buffer_load_dwordx4 v14, s[32:35], s64 offen offset:0 lds
    buffer_load_dwordx4 v15, s[32:35], s64 offen offset:1024 lds
    buffer_load_dwordx4 v16, s[32:35], s64 offen offset:2048 lds
    buffer_load_dwordx4 v17, s[32:35], s64 offen offset:3072 lds
    s_add_u32 s63, s63, 128
    s_add_u32 s64, s64, 524288
    s_cmp_eq_u32 s63, s25
    s_cselect_b32 s63, s69, s63
    s_cselect_b32 s64, s71, s64
    s_waitcnt vmcnt(16)
    s_waitcnt vmcnt(12)
    s_barrier
    s_add_u32 m0, s74, 0
    s_nop 0
    buffer_load_dwordx4 v10, s[28:31], s63 offen offset:0 lds
    buffer_load_dwordx4 v11, s[28:31], s63 offen offset:1024 lds
    buffer_load_dwordx4 v12, s[28:31], s63 offen offset:2048 lds
    buffer_load_dwordx4 v13, s[28:31], s63 offen offset:3072 lds
    s_add_u32 m0, s74, 16384
    s_nop 0
    buffer_load_dwordx4 v14, s[32:35], s64 offen offset:0 lds
    buffer_load_dwordx4 v15, s[32:35], s64 offen offset:1024 lds
    buffer_load_dwordx4 v16, s[32:35], s64 offen offset:2048 lds
    buffer_load_dwordx4 v17, s[32:35], s64 offen offset:3072 lds
    s_add_u32 s63, s63, 128
    s_add_u32 s64, s64, 524288
    s_cmp_eq_u32 s63, s25
    s_cselect_b32 s63, s69, s63
    s_cselect_b32 s64, s71, s64
    s_add_u32 m0, s74, 114688
    s_add_u32 s75, s76, 1
    s_and_b32 s75, s75, 7
    s_lshl_b32 s75, s75, 14
    s_add_u32 s75, s75, s74
    buffer_load_dwordx4 v18, s[36:39], s75 offen offset:0 nt lds
    buffer_load_dwordx4 v19, s[36:39], s75 offen offset:1024 nt lds
    buffer_load_dwordx4 v20, s[36:39], s75 offen offset:2048 nt lds
    buffer_load_dwordx4 v21, s[36:39], s75 offen offset:3072 nt lds
    s_waitcnt vmcnt(16)
    s_waitcnt vmcnt(12)
    s_barrier
    s_add_u32 m0, s74, 32768
    s_nop 0
    buffer_load_dwordx4 v10, s[28:31], s63 offen offset:0 lds
    buffer_load_dwordx4 v11, s[28:31], s63 offen offset:1024 lds
    buffer_load_dwordx4 v12, s[28:31], s63 offen offset:2048 lds
    buffer_load_dwordx4 v13, s[28:31], s63 offen offset:3072 lds
    s_add_u32 m0, s74, 49152
    s_nop 0
    buffer_load_dwordx4 v14, s[32:35], s64 offen offset:0 lds
    buffer_load_dwordx4 v15, s[32:35], s64 offen offset:1024 lds
    buffer_load_dwordx4 v16, s[32:35], s64 offen offset:2048 lds
    buffer_load_dwordx4 v17, s[32:35], s64 offen offset:3072 lds
    s_add_u32 s63, s63, 128
    s_add_u32 s64, s64, 524288
    s_cmp_eq_u32 s63, s25
    s_cselect_b32 s63, s69, s63
    s_cselect_b32 s64, s71, s64
    s_waitcnt vmcnt(16)
    s_waitcnt vmcnt(12)
    s_barrier
    s_add_u32 m0, s74, 65536
    s_nop 0
    buffer_load_dwordx4 v10, s[28:31], s63 offen offset:0 lds
    buffer_load_dwordx4 v11, s[28:31], s63 offen offset:1024 lds
    buffer_load_dwordx4 v12, s[28:31], s63 offen offset:2048 lds
    buffer_load_dwordx4 v13, s[28:31], s63 offen offset:3072 lds
    s_add_u32 m0, s74, 81920
    s_nop 0
    buffer_load_dwordx4 v14, s[32:35], s64 offen offset:0 lds
    buffer_load_dwordx4 v15, s[32:35], s64 offen offset:1024 lds
    buffer_load_dwordx4 v16, s[32:35], s64 offen offset:2048 lds
    buffer_load_dwordx4 v17, s[32:35], s64 offen offset:3072 lds
    s_add_u32 s63, s63, 128
    s_add_u32 s64, s64, 524288
    s_cmp_eq_u32 s63, s25
    s_cselect_b32 s63, s69, s63
    s_cselect_b32 s64, s71, s64
    s_add_u32 m0, s74, 131072
    s_add_u32 s75, s76, 0
    s_and_b32 s75, s75, 7
    s_lshl_b32 s75, s75, 14
    s_add_u32 s75, s75, s74
    buffer_load_dwordx4 v22, s[40:43], s75 offen offset:0 nt lds
    buffer_load_dwordx4 v22, s[40:43], s75 offen offset:1024 nt lds
    buffer_load_dwordx4 v22, s[40:43], s75 offen offset:2048 nt lds
    buffer_load_dwordx4 v22, s[40:43], s75 offen offset:3072 nt lds
    s_waitcnt vmcnt(16)
    s_waitcnt vmcnt(12)
    s_barrier
    s_add_u32 m0, s74, 0
    s_nop 0
    buffer_load_dwordx4 v10, s[28:31], s63 offen offset:0 lds
    buffer_load_dwordx4 v11, s[28:31], s63 offen offset:1024 lds
    buffer_load_dwordx4 v12, s[28:31], s63 offen offset:2048 lds
    buffer_load_dwordx4 v13, s[28:31], s63 offen offset:3072 lds
    s_add_u32 m0, s74, 16384
    s_nop 0
    buffer_load_dwordx4 v14, s[32:35], s64 offen offset:0 lds
    buffer_load_dwordx4 v15, s[32:35], s64 offen offset:1024 lds
    buffer_load_dwordx4 v16, s[32:35], s64 offen offset:2048 lds
    buffer_load_dwordx4 v17, s[32:35], s64 offen offset:3072 lds
    s_add_u32 s63, s63, 128
    s_add_u32 s64, s64, 524288
    s_cmp_eq_u32 s63, s25
    s_cselect_b32 s63, s69, s63
    s_cselect_b32 s64, s71, s64
    s_add_u32 m0, s74, 147456
    s_add_u32 s75, s76, 2
    s_and_b32 s75, s75, 7
    s_lshl_b32 s75, s75, 14
    s_add_u32 s75, s75, s74
    buffer_load_dwordx4 v18, s[36:39], s75 offen offset:0 nt lds
    buffer_load_dwordx4 v19, s[36:39], s75 offen offset:1024 nt lds
    buffer_load_dwordx4 v20, s[36:39], s75 offen offset:2048 nt lds
    buffer_load_dwordx4 v21, s[36:39], s75 offen offset:3072 nt lds
    s_waitcnt vmcnt(20)
    s_waitcnt vmcnt(16)
    s_barrier
    s_add_u32 m0, s74, 32768
    s_add_u32 s75, s76, 1
    s_and_b32 s75, s75, 7
    s_lshl_b32 s75, s75, 14
    s_add_u32 s75, s75, s74
    buffer_load_dwordx4 v22, s[40:43], s75 offen offset:0 nt lds
    buffer_load_dwordx4 v22, s[40:43], s75 offen offset:1024 nt lds
    buffer_load_dwordx4 v22, s[40:43], s75 offen offset:2048 nt lds
    buffer_load_dwordx4 v22, s[40:43], s75 offen offset:3072 nt lds
    s_waitcnt vmcnt(12)
    s_waitcnt vmcnt(8)
    s_barrier
    s_add_u32 m0, s74, 49152
    s_add_u32 s75, s76, 3
    s_and_b32 s75, s75, 7
    s_lshl_b32 s75, s75, 14
    s_add_u32 s75, s75, s74
    buffer_load_dwordx4 v18, s[36:39], s75 offen offset:0 nt lds
    buffer_load_dwordx4 v19, s[36:39], s75 offen offset:1024 nt lds
    buffer_load_dwordx4 v20, s[36:39], s75 offen offset:2048 nt lds
    buffer_load_dwordx4 v21, s[36:39], s75 offen offset:3072 nt lds
    s_barrier
    s_add_u32 m0, s74, 65536
    s_add_u32 s75, s76, 2
    s_and_b32 s75, s75, 7
    s_lshl_b32 s75, s75, 14
    s_add_u32 s75, s75, s74
    buffer_load_dwordx4 v22, s[40:43], s75 offen offset:0 nt lds
    buffer_load_dwordx4 v22, s[40:43], s75 offen offset:1024 nt lds
    buffer_load_dwordx4 v22, s[40:43], s75 offen offset:2048 nt lds
    buffer_load_dwordx4 v22, s[40:43], s75 offen offset:3072 nt lds
    s_barrier
    s_add_u32 m0, s74, 81920
    s_add_u32 s75, s76, 4
    s_and_b32 s75, s75, 7
    s_lshl_b32 s75, s75, 14
    s_add_u32 s75, s75, s74
    buffer_load_dwordx4 v18, s[36:39], s75 offen offset:0 nt lds
    buffer_load_dwordx4 v19, s[36:39], s75 offen offset:1024 nt lds
    buffer_load_dwordx4 v20, s[36:39], s75 offen offset:2048 nt lds
    buffer_load_dwordx4 v21, s[36:39], s75 offen offset:3072 nt lds
    s_mul_i32 s65, s21, 589824
    s_mul_i32 s68, s22, 288
    s_add_u32 s65, s65, s68
    s_add_u32 s44, s12, s65
    s_addc_u32 s45, s13, 0
    s_sub_u32 s46, 4718592, s65
    s_mov_b32 s47, 0x20000
    s_mul_i32 s78, s20, 9216
    v_add_u32 v2, 0, v1
    v_mul_u32_u24 v3, 911, v2
    v_lshrrev_b32 v3, 16, v3
    v_mul_u32_u24 v4, 72, v3
    v_sub_u32 v2, v2, v4
    v_lshrrev_b32 v4, 4, v2
    v_bfe_u32 v5, v2, 2, 2
    v_xor_b32 v5, v5, v4
    v_lshlrev_b32 v5, 2, v5
    v_and_b32 v6, 3, v2
    v_add_u32 v6, v6, v5
    v_bfe_u32 v7, v2, 1, 2
    v_and_b32 v8, 1, v2
    v_add_u32 v8, 16, v8
    v_cmp_lt_u32 vcc, 63, v2
    v_lshlrev_b32 v3, 2, v3
    s_nop 0
    v_cndmask_b32 v4, v4, v7, vcc
    v_cndmask_b32 v6, v6, v8, vcc
    v_add_u32 v3, v3, v4
    v_mul_u32_u24 v3, 1152, v3
    v_lshlrev_b32 v6, 4, v6
    v_add_u32 v23, v6, v3
    v_add_u32 v2, 64, v1
    v_mul_u32_u24 v3, 911, v2
    v_lshrrev_b32 v3, 16, v3
    v_mul_u32_u24 v4, 72, v3
    v_sub_u32 v2, v2, v4
    v_lshrrev_b32 v4, 4, v2
    v_bfe_u32 v5, v2, 2, 2
    v_xor_b32 v5, v5, v4
    v_lshlrev_b32 v5, 2, v5
    v_and_b32 v6, 3, v2
    v_add_u32 v6, v6, v5
    v_bfe_u32 v7, v2, 1, 2
    v_and_b32 v8, 1, v2
    v_add_u32 v8, 16, v8
    v_cmp_lt_u32 vcc, 63, v2
    v_lshlrev_b32 v3, 2, v3
    s_nop 0
    v_cndmask_b32 v4, v4, v7, vcc
    v_cndmask_b32 v6, v6, v8, vcc
    v_add_u32 v3, v3, v4
    v_mul_u32_u24 v3, 1152, v3
    v_lshlrev_b32 v6, 4, v6
    v_add_u32 v24, v6, v3
    v_subrev_u32 v24, 1024, v24
    v_add_u32 v2, 128, v1
    v_mul_u32_u24 v3, 911, v2
    v_lshrrev_b32 v3, 16, v3
    v_mul_u32_u24 v4, 72, v3
    v_sub_u32 v2, v2, v4
    v_lshrrev_b32 v4, 4, v2
    v_bfe_u32 v5, v2, 2, 2
    v_xor_b32 v5, v5, v4
    v_lshlrev_b32 v5, 2, v5
    v_and_b32 v6, 3, v2
    v_add_u32 v6, v6, v5
    v_bfe_u32 v7, v2, 1, 2
    v_and_b32 v8, 1, v2
    v_add_u32 v8, 16, v8
    v_cmp_lt_u32 vcc, 63, v2
    v_lshlrev_b32 v3, 2, v3
    s_nop 0
    v_cndmask_b32 v4, v4, v7, vcc
    v_cndmask_b32 v6, v6, v8, vcc
    v_add_u32 v3, v3, v4
    v_mul_u32_u24 v3, 1152, v3
    v_lshlrev_b32 v6, 4, v6
    v_add_u32 v25, v6, v3
    v_subrev_u32 v25, 2048, v25
    v_add_u32 v2, 192, v1
    v_mul_u32_u24 v3, 911, v2
    v_lshrrev_b32 v3, 16, v3
    v_mul_u32_u24 v4, 72, v3
    v_sub_u32 v2, v2, v4
    v_lshrrev_b32 v4, 4, v2
    v_bfe_u32 v5, v2, 2, 2
    v_xor_b32 v5, v5, v4
    v_lshlrev_b32 v5, 2, v5
    v_and_b32 v6, 3, v2
    v_add_u32 v6, v6, v5
    v_bfe_u32 v7, v2, 1, 2
    v_and_b32 v8, 1, v2
    v_add_u32 v8, 16, v8
    v_cmp_lt_u32 vcc, 63, v2
    v_lshlrev_b32 v3, 2, v3
    s_nop 0
    v_cndmask_b32 v4, v4, v7, vcc
    v_cndmask_b32 v6, v6, v8, vcc
    v_add_u32 v3, v3, v4
    v_mul_u32_u24 v3, 1152, v3
    v_lshlrev_b32 v6, 4, v6
    v_add_u32 v26, v6, v3
    v_subrev_u32 v26, 3072, v26
    v_add_u32 v2, 256, v1
    v_mul_u32_u24 v3, 911, v2
    v_lshrrev_b32 v3, 16, v3
    v_mul_u32_u24 v4, 72, v3
    v_sub_u32 v2, v2, v4
    v_lshrrev_b32 v4, 4, v2
    v_bfe_u32 v5, v2, 2, 2
    v_xor_b32 v5, v5, v4
    v_lshlrev_b32 v5, 2, v5
    v_and_b32 v6, 3, v2
    v_add_u32 v6, v6, v5
    v_bfe_u32 v7, v2, 1, 2
    v_and_b32 v8, 1, v2
    v_add_u32 v8, 16, v8
    v_cmp_lt_u32 vcc, 63, v2
    v_lshlrev_b32 v3, 2, v3
    s_nop 0
    v_cndmask_b32 v4, v4, v7, vcc
    v_cndmask_b32 v6, v6, v8, vcc
    v_add_u32 v3, v3, v4
    v_mul_u32_u24 v3, 1152, v3
    v_lshlrev_b32 v6, 4, v6
    v_add_u32 v27, v6, v3
    v_add_u32 v2, 320, v1
    v_mul_u32_u24 v3, 911, v2
    v_lshrrev_b32 v3, 16, v3
    v_mul_u32_u24 v4, 72, v3
    v_sub_u32 v2, v2, v4
    v_lshrrev_b32 v4, 4, v2
    v_bfe_u32 v5, v2, 2, 2
    v_xor_b32 v5, v5, v4
    v_lshlrev_b32 v5, 2, v5
    v_and_b32 v6, 3, v2
    v_add_u32 v6, v6, v5
    v_bfe_u32 v7, v2, 1, 2
    v_and_b32 v8, 1, v2
    v_add_u32 v8, 16, v8
    v_cmp_lt_u32 vcc, 63, v2
    v_lshlrev_b32 v3, 2, v3
    s_nop 0
    v_cndmask_b32 v4, v4, v7, vcc
    v_cndmask_b32 v6, v6, v8, vcc
    v_add_u32 v3, v3, v4
    v_mul_u32_u24 v3, 1152, v3
    v_lshlrev_b32 v6, 4, v6
    v_add_u32 v28, v6, v3
    v_subrev_u32 v28, 1024, v28
    v_add_u32 v2, 384, v1
    v_mul_u32_u24 v3, 911, v2
    v_lshrrev_b32 v3, 16, v3
    v_mul_u32_u24 v4, 72, v3
    v_sub_u32 v2, v2, v4
    v_lshrrev_b32 v4, 4, v2
    v_bfe_u32 v5, v2, 2, 2
    v_xor_b32 v5, v5, v4
    v_lshlrev_b32 v5, 2, v5
    v_and_b32 v6, 3, v2
    v_add_u32 v6, v6, v5
    v_bfe_u32 v7, v2, 1, 2
    v_and_b32 v8, 1, v2
    v_add_u32 v8, 16, v8
    v_cmp_lt_u32 vcc, 63, v2
    v_lshlrev_b32 v3, 2, v3
    s_nop 0
    v_cndmask_b32 v4, v4, v7, vcc
    v_cndmask_b32 v6, v6, v8, vcc
    v_add_u32 v3, v3, v4
    v_mul_u32_u24 v3, 1152, v3
    v_lshlrev_b32 v6, 4, v6
    v_add_u32 v29, v6, v3
    v_subrev_u32 v29, 2048, v29
    v_add_u32 v2, 448, v1
    v_mul_u32_u24 v3, 911, v2
    v_lshrrev_b32 v3, 16, v3
    v_mul_u32_u24 v4, 72, v3
    v_sub_u32 v2, v2, v4
    v_lshrrev_b32 v4, 4, v2
    v_bfe_u32 v5, v2, 2, 2
    v_xor_b32 v5, v5, v4
    v_lshlrev_b32 v5, 2, v5
    v_and_b32 v6, 3, v2
    v_add_u32 v6, v6, v5
    v_bfe_u32 v7, v2, 1, 2
    v_and_b32 v8, 1, v2
    v_add_u32 v8, 16, v8
    v_cmp_lt_u32 vcc, 63, v2
    v_lshlrev_b32 v3, 2, v3
    s_nop 0
    v_cndmask_b32 v4, v4, v7, vcc
    v_cndmask_b32 v6, v6, v8, vcc
    v_add_u32 v3, v3, v4
    v_mul_u32_u24 v3, 1152, v3
    v_lshlrev_b32 v6, 4, v6
    v_add_u32 v30, v6, v3
    v_subrev_u32 v30, 3072, v30
    v_add_u32 v2, 512, v1
    v_mul_u32_u24 v3, 911, v2
    v_lshrrev_b32 v3, 16, v3
    v_mul_u32_u24 v4, 72, v3
    v_sub_u32 v2, v2, v4
    v_lshrrev_b32 v4, 4, v2
    v_bfe_u32 v5, v2, 2, 2
    v_xor_b32 v5, v5, v4
    v_lshlrev_b32 v5, 2, v5
    v_and_b32 v6, 3, v2
    v_add_u32 v6, v6, v5
    v_bfe_u32 v7, v2, 1, 2
    v_and_b32 v8, 1, v2
    v_add_u32 v8, 16, v8
    v_cmp_lt_u32 vcc, 63, v2
    v_lshlrev_b32 v3, 2, v3
    s_nop 0
    v_cndmask_b32 v4, v4, v7, vcc
    v_cndmask_b32 v6, v6, v8, vcc
    v_add_u32 v3, v3, v4
    v_mul_u32_u24 v3, 1152, v3
    v_lshlrev_b32 v6, 4, v6
    v_add_u32 v31, v6, v3
    s_waitcnt vmcnt(12)
    s_barrier
    s_add_u32 m0, s74, 98304
    s_add_u32 s75, s76, 3
    s_and_b32 s75, s75, 7
    s_lshl_b32 s75, s75, 14
    s_add_u32 s75, s75, s74
    buffer_load_dwordx4 v22, s[40:43], s75 offen offset:0 nt lds
    buffer_load_dwordx4 v22, s[40:43], s75 offen offset:1024 nt lds
    buffer_load_dwordx4 v22, s[40:43], s75 offen offset:2048 nt lds
    buffer_load_dwordx4 v22, s[40:43], s75 offen offset:3072 nt lds
    s_add_u32 m0, s74, 114688
    s_add_u32 s75, s76, 5
    s_and_b32 s75, s75, 7
    s_lshl_b32 s75, s75, 14
    s_add_u32 s75, s75, s74
    buffer_load_dwordx4 v18, s[36:39], s75 offen offset:0 nt lds
    buffer_load_dwordx4 v19, s[36:39], s75 offen offset:1024 nt lds
    buffer_load_dwordx4 v20, s[36:39], s75 offen offset:2048 nt lds
    buffer_load_dwordx4 v21, s[36:39], s75 offen offset:3072 nt lds
    s_waitcnt vmcnt(12)
    s_barrier
    s_add_u32 m0, s78, 0
    s_add_u32 s77, s22, 0
    s_and_b32 s77, s77, 3
    s_mul_i32 s77, s77, 147456
    s_add_u32 s77, s77, s69
    buffer_load_dwordx4 v23, s[44:47], s77 offen offset:0 lds
    buffer_load_dwordx4 v24, s[44:47], s77 offen offset:1024 lds
    buffer_load_dwordx4 v25, s[44:47], s77 offen offset:2048 lds
    s_add_u32 m0, s74, 131072
    s_add_u32 s75, s76, 4
    s_and_b32 s75, s75, 7
    s_lshl_b32 s75, s75, 14
    s_add_u32 s75, s75, s74
    buffer_load_dwordx4 v22, s[40:43], s75 offen offset:0 nt lds
    buffer_load_dwordx4 v22, s[40:43], s75 offen offset:1024 nt lds
    buffer_load_dwordx4 v22, s[40:43], s75 offen offset:2048 nt lds
    buffer_load_dwordx4 v22, s[40:43], s75 offen offset:3072 nt lds
    s_add_u32 m0, s78, 0
    s_add_u32 s77, s22, 0
    s_and_b32 s77, s77, 3
    s_mul_i32 s77, s77, 147456
    s_add_u32 s77, s77, s69
    buffer_load_dwordx4 v26, s[44:47], s77 offen offset:3072 lds
    s_add_u32 m0, s78, 4096
    s_nop 0
    buffer_load_dwordx4 v27, s[44:47], s77 offen offset:0 lds
    buffer_load_dwordx4 v28, s[44:47], s77 offen offset:1024 lds
    s_waitcnt vmcnt(14)
    s_barrier
    s_add_u32 m0, s78, 4096
    s_add_u32 s77, s22, 0
    s_and_b32 s77, s77, 3
    s_mul_i32 s77, s77, 147456
    s_add_u32 s77, s77, s69
    buffer_load_dwordx4 v29, s[44:47], s77 offen offset:2048 lds
    buffer_load_dwordx4 v30, s[44:47], s77 offen offset:3072 lds
    s_add_u32 m0, s78, 8192
    s_nop 0
    buffer_load_dwordx4 v31, s[44:47], s77 offen offset:0 lds
    s_add_u32 m0, s74, 147456
    s_add_u32 s75, s76, 6
    s_and_b32 s75, s75, 7
    s_lshl_b32 s75, s75, 14
    s_add_u32 s75, s75, s74
    buffer_load_dwordx4 v18, s[36:39], s75 offen offset:0 nt lds
    buffer_load_dwordx4 v19, s[36:39], s75 offen offset:1024 nt lds
    buffer_load_dwordx4 v20, s[36:39], s75 offen offset:2048 nt lds
    buffer_load_dwordx4 v21, s[36:39], s75 offen offset:3072 nt lds
    s_add_u32 m0, s78, 36864
    s_add_u32 s77, s22, 1
    s_and_b32 s77, s77, 3
    s_mul_i32 s77, s77, 147456
    s_add_u32 s77, s77, s69
    buffer_load_dwordx4 v23, s[44:47], s77 offen offset:0 lds
    buffer_load_dwordx4 v24, s[44:47], s77 offen offset:1024 lds
    buffer_load_dwordx4 v25, s[44:47], s77 offen offset:2048 lds
    s_waitcnt vmcnt(20)
    s_barrier
    s_add_u32 m0, s74, 98304
    s_add_u32 s75, s76, 5
    s_and_b32 s75, s75, 7
    s_lshl_b32 s75, s75, 14
    s_add_u32 s75, s75, s74
    buffer_load_dwordx4 v22, s[40:43], s75 offen offset:0 nt lds
    buffer_load_dwordx4 v22, s[40:43], s75 offen offset:1024 nt lds
    buffer_load_dwordx4 v22, s[40:43], s75 offen offset:2048 nt lds
    buffer_load_dwordx4 v22, s[40:43], s75 offen offset:3072 nt lds
    s_add_u32 m0, s78, 36864
    s_add_u32 s77, s22, 1
    s_and_b32 s77, s77, 3
    s_mul_i32 s77, s77, 147456
    s_add_u32 s77, s77, s69
    buffer_load_dwordx4 v26, s[44:47], s77 offen offset:3072 lds
    s_add_u32 m0, s78, 40960
    s_nop 0
    buffer_load_dwordx4 v27, s[44:47], s77 offen offset:0 lds
    buffer_load_dwordx4 v28, s[44:47], s77 offen offset:1024 lds
    s_waitcnt vmcnt(20)
    s_barrier
    s_add_u32 m0, s74, 114688
    s_add_u32 s75, s76, 7
    s_and_b32 s75, s75, 7
    s_lshl_b32 s75, s75, 14
    s_add_u32 s75, s75, s74
    buffer_load_dwordx4 v18, s[36:39], s75 offen offset:0 nt lds
    buffer_load_dwordx4 v19, s[36:39], s75 offen offset:1024 nt lds
    buffer_load_dwordx4 v20, s[36:39], s75 offen offset:2048 nt lds
    buffer_load_dwordx4 v21, s[36:39], s75 offen offset:3072 nt lds
    s_add_u32 m0, s78, 40960
    s_add_u32 s77, s22, 1
    s_and_b32 s77, s77, 3
    s_mul_i32 s77, s77, 147456
    s_add_u32 s77, s77, s69
    buffer_load_dwordx4 v29, s[44:47], s77 offen offset:2048 lds
    buffer_load_dwordx4 v30, s[44:47], s77 offen offset:3072 lds
    s_add_u32 m0, s78, 45056
    s_nop 0
    buffer_load_dwordx4 v31, s[44:47], s77 offen offset:0 lds
    s_waitcnt vmcnt(17)
    s_barrier
    s_add_u32 m0, s74, 131072
    s_add_u32 s75, s76, 6
    s_and_b32 s75, s75, 7
    s_lshl_b32 s75, s75, 14
    s_add_u32 s75, s75, s74
    buffer_load_dwordx4 v22, s[40:43], s75 offen offset:0 nt lds
    buffer_load_dwordx4 v22, s[40:43], s75 offen offset:1024 nt lds
    buffer_load_dwordx4 v22, s[40:43], s75 offen offset:2048 nt lds
    buffer_load_dwordx4 v22, s[40:43], s75 offen offset:3072 nt lds
    s_waitcnt vmcnt(14)
    s_barrier
    s_add_u32 m0, s74, 147456
    s_add_u32 s75, s76, 7
    s_and_b32 s75, s75, 7
    s_lshl_b32 s75, s75, 14
    s_add_u32 s75, s75, s74
    buffer_load_dwordx4 v22, s[40:43], s75 offen offset:0 nt lds
    buffer_load_dwordx4 v22, s[40:43], s75 offen offset:1024 nt lds
    buffer_load_dwordx4 v22, s[40:43], s75 offen offset:2048 nt lds
    buffer_load_dwordx4 v22, s[40:43], s75 offen offset:3072 nt lds
    s_waitcnt vmcnt(11)
    s_barrier
    s_add_u32 m0, s78, 73728
    s_add_u32 s77, s22, 2
    s_and_b32 s77, s77, 3
    s_mul_i32 s77, s77, 147456
    s_add_u32 s77, s77, s69
    buffer_load_dwordx4 v23, s[44:47], s77 offen offset:0 lds
    buffer_load_dwordx4 v24, s[44:47], s77 offen offset:1024 lds
    buffer_load_dwordx4 v25, s[44:47], s77 offen offset:2048 lds
    buffer_load_dwordx4 v26, s[44:47], s77 offen offset:3072 lds
    s_add_u32 m0, s78, 77824
    s_nop 0
    buffer_load_dwordx4 v27, s[44:47], s77 offen offset:0 lds
    s_waitcnt vmcnt(9)
    s_barrier
    s_add_u32 m0, s78, 77824
    s_add_u32 s77, s22, 2
    s_and_b32 s77, s77, 3
    s_mul_i32 s77, s77, 147456
    s_add_u32 s77, s77, s69
    buffer_load_dwordx4 v28, s[44:47], s77 offen offset:1024 lds
    buffer_load_dwordx4 v29, s[44:47], s77 offen offset:2048 lds
    buffer_load_dwordx4 v30, s[44:47], s77 offen offset:3072 lds
    s_add_u32 m0, s78, 81920
    s_nop 0
    buffer_load_dwordx4 v31, s[44:47], s77 offen offset:0 lds
    s_waitcnt vmcnt(9)
    s_barrier
    s_add_u32 m0, s78, 110592
    s_add_u32 s77, s22, 3
    s_and_b32 s77, s77, 3
    s_mul_i32 s77, s77, 147456
    s_add_u32 s77, s77, s69
    buffer_load_dwordx4 v23, s[44:47], s77 offen offset:0 lds
    buffer_load_dwordx4 v24, s[44:47], s77 offen offset:1024 lds
    buffer_load_dwordx4 v25, s[44:47], s77 offen offset:2048 lds
    buffer_load_dwordx4 v26, s[44:47], s77 offen offset:3072 lds
    s_add_u32 m0, s78, 114688
    s_nop 0
    buffer_load_dwordx4 v27, s[44:47], s77 offen offset:0 lds
    buffer_load_dwordx4 v28, s[44:47], s77 offen offset:1024 lds
    buffer_load_dwordx4 v29, s[44:47], s77 offen offset:2048 lds
    buffer_load_dwordx4 v30, s[44:47], s77 offen offset:3072 lds
    s_add_u32 m0, s78, 118784
    s_nop 0
    buffer_load_dwordx4 v31, s[44:47], s77 offen offset:0 lds
    s_waitcnt vmcnt(0)
    s_barrier
    s_endpgm
L_compute:
    v_and_b32 v2, 31, v1
    v_lshrrev_b32 v3, 5, v1
    v_bfe_u32 v4, v1, 4, 1
    v_bfe_u32 v5, v1, 2, 2
    v_and_b32 v0, 3, v1
    v_bfe_u32 v6, v2, 1, 3
    v_xor_b32 v6, v6, v3
    v_lshlrev_b32 v6, 4, v6
    v_lshlrev_b32 v7, 7, v2
    v_add_u32 v7, s74, v7
    v_xor_b32 v8, 0, v6
    v_add_u32 v8, v8, v7
    v_add_u32 v12, 65536, v8
    v_xor_b32 v9, 32, v6
    v_add_u32 v9, v9, v7
    v_add_u32 v13, 65536, v9
    v_xor_b32 v10, 64, v6
    v_add_u32 v10, v10, v7
    v_add_u32 v14, 65536, v10
    v_xor_b32 v11, 96, v6
    v_add_u32 v11, v11, v7
    v_add_u32 v15, 65536, v11
    v_lshlrev_b32 v7, 3, v3
    v_add_u32 v7, v7, v5
    v_lshlrev_b32 v7, 8, v7
    v_lshlrev_b32 v6, 5, v4
    v_add_u32 v7, v7, v6
    v_and_b32 v6, 1, v0
    v_lshlrev_b32 v6, 4, v6
    v_add_u32 v7, v7, v6
    v_lshrrev_b32 v6, 1, v0
    v_lshlrev_b32 v6, 3, v6
    v_add_u32 v7, v7, v6
    v_xor_b32 v6, 0, v5
    v_lshlrev_b32 v6, 6, v6
    v_add_u32 v16, v6, v7
    v_add_u32 v20, 65536, v16
    v_xor_b32 v6, 1, v5
    v_lshlrev_b32 v6, 6, v6
    v_add_u32 v17, v6, v7
    v_add_u32 v21, 65536, v17
    v_xor_b32 v6, 2, v5
    v_lshlrev_b32 v6, 6, v6
    v_add_u32 v18, v6, v7
    v_add_u32 v22, 65536, v18
    v_xor_b32 v6, 3, v5
    v_lshlrev_b32 v6, 6, v6
    v_add_u32 v19, v6, v7
    v_add_u32 v23, 65536, v19
    v_lshlrev_b32 v7, 2, v3
    v_add_u32 v7, v7, v5
    v_lshlrev_b32 v7, 8, v7
    v_lshlrev_b32 v6, 5, v4
    v_add_u32 v7, v7, v6
    v_lshlrev_b32 v6, 3, v0
    v_add_u32 v7, v7, v6
    v_add_u32 v7, 131072, v7
    v_xor_b32 v6, 0, v5
    v_lshlrev_b32 v6, 6, v6
    v_add_u32 v32, v6, v7
    v_xor_b32 v6, 1, v5
    v_lshlrev_b32 v6, 6, v6
    v_add_u32 v33, v6, v7
    v_xor_b32 v6, 2, v5
    v_lshlrev_b32 v6, 6, v6
    v_add_u32 v34, v6, v7
    v_xor_b32 v6, 3, v5
    v_lshlrev_b32 v6, 6, v6
    v_add_u32 v35, v6, v7
    v_and_b32 v6, 15, v2
    v_xor_b32 v6, v6, v3
    v_lshlrev_b32 v6, 4, v6
    v_lshlrev_b32 v7, 8, v2
    v_add_u32 v7, 98304, v7
    v_xor_b32 v24, 0, v6
    v_add_u32 v24, v24, v7
    v_xor_b32 v25, 32, v6
    v_add_u32 v25, v25, v7
    v_xor_b32 v26, 64, v6
    v_add_u32 v26, v26, v7
    v_xor_b32 v27, 96, v6
    v_add_u32 v27, v27, v7
    v_xor_b32 v28, 128, v6
    v_add_u32 v28, v28, v7
    v_xor_b32 v29, 160, v6
    v_add_u32 v29, v29, v7
    v_xor_b32 v30, 192, v6
    v_add_u32 v30, v30, v7
    v_xor_b32 v31, 224, v6
    v_add_u32 v31, v31, v7
    v_mov_b32 v6, 0x3f803f80
    v_accvgpr_write_b32 a32, v6
    v_accvgpr_write_b32 a33, v6
    v_accvgpr_write_b32 a34, v6
    v_accvgpr_write_b32 a35, v6
    s_waitcnt lgkmcnt(0)
    s_lshl_b32 s65, s23, 3
    s_add_u32 s65, s65, s21
    s_lshl_b32 s65, s65, 2
    s_add_u32 s65, s65, s20
    s_lshl_b32 s65, s65, 15
    s_add_u32 s48, s18, s65
    s_addc_u32 s49, s19, 0
    s_mov_b32 s50, 32768
    s_mov_b32 s51, 0x20000
    s_mov_b32 s60, 0x3e0293ee
    s_mov_b32 s61, 0x3e0293ee
    s_getreg_b32 s26, hwreg(HW_REG_XCC_ID, 0, 3)
    s_lshl_b32 s65, s23, 2
    s_add_u32 s65, s65, s22
    s_mul_i32 s65, s65, 294912
    s_add_u32 s65, s65, 8388608
    s_add_u32 s52, s18, s65
    s_addc_u32 s53, s19, 0
    s_mov_b32 s54, 294912
    s_mov_b32 s55, 0x20000
    s_lshl_b32 s62, s20, 4
    s_add_u32 s62, s62, s21
    s_mul_i32 s62, s62, 4608
    s_add_u32 s3, s62, 4096
    s_lshl_b32 s65, s23, 7
    s_lshl_b32 s66, s21, 4
    s_add_u32 s65, s65, s66
    s_mul_i32 s65, s65, 1152
    s_mul_i32 s66, s22, 288
    s_add_u32 s65, s65, s66
    s_add_u32 s56, s14, s65
    s_addc_u32 s57, s15, 0
    s_sub_u32 s58, 1179648, s65
    s_mov_b32 s59, 0x20000
    s_or_b32 s65, s2, s20
    s_cmp_lg_u32 s65, 0
    s_cbranch_scc1 L_nononce
    s_memrealtime s[66:67]
    s_waitcnt lgkmcnt(0)
    s_lshl_b32 s66, s66, 4
    s_or_b32 s66, s66, 8
    v_mov_b32 v6, s66
    v_mov_b32 v7, 0
    s_mov_b64 exec, 1
    global_store_dword v7, v6, s[16:17] sc0 sc1
    s_mov_b64 exec, -1
L_nononce:
    v_mov_b32 v2, 0
    s_lshl_b32 s79, s23, 3
    s_add_u32 s79, s79, s21
    s_lshl_b32 s79, s79, 6
    s_add_u32 s79, s79, 33685504
    s_barrier
    ds_read_b128 v[44:47], v8 offset:32768
    ds_read_b64_tr_b16 a[52:53], v16 offset:49152
    ds_read_b64_tr_b16 a[54:55], v16 offset:50176
    ds_read_b64_tr_b16 a[56:57], v17 offset:49152
    ds_read_b64_tr_b16 a[58:59], v17 offset:50176
    ds_read_b64_tr_b16 a[60:61], v18 offset:49152
    ds_read_b64_tr_b16 a[62:63], v18 offset:50176
    ds_read_b64_tr_b16 a[64:65], v19 offset:49152
    ds_read_b64_tr_b16 a[66:67], v19 offset:50176
    s_waitcnt lgkmcnt(4)
    v_mfma_f32_32x32x16_bf16 v[124:139], a[52:55], v[44:47], 0
    ds_read_b128 v[48:51], v9 offset:32768
    ds_read_b64_tr_b16 a[52:53], v16 offset:53248
    ds_read_b64_tr_b16 a[54:55], v16 offset:54272
    v_mfma_f32_32x32x16_bf16 v[140:155], a[56:59], v[44:47], 0
    ds_read_b64_tr_b16 a[56:57], v17 offset:53248
    ds_read_b64_tr_b16 a[58:59], v17 offset:54272
    s_waitcnt lgkmcnt(5)
    v_mfma_f32_32x32x16_bf16 v[156:171], a[60:63], v[44:47], 0
    ds_read_b64_tr_b16 a[60:61], v18 offset:53248
    ds_read_b64_tr_b16 a[62:63], v18 offset:54272
    v_mfma_f32_32x32x16_bf16 v[172:187], a[64:67], v[44:47], 0
    ds_read_b64_tr_b16 a[64:65], v19 offset:53248
    ds_read_b64_tr_b16 a[66:67], v19 offset:54272
    s_waitcnt lgkmcnt(4)
    v_mfma_f32_32x32x16_bf16 v[124:139], a[52:55], v[48:51], v[124:139]
    ds_read_b128 v[52:55], v10 offset:32768
    ds_read_b64_tr_b16 a[52:53], v16 offset:57344
    ds_read_b64_tr_b16 a[54:55], v16 offset:58368
    v_mfma_f32_32x32x16_bf16 v[140:155], a[56:59], v[48:51], v[140:155]
    ds_read_b64_tr_b16 a[56:57], v17 offset:57344
    ds_read_b64_tr_b16 a[58:59], v17 offset:58368
    s_waitcnt lgkmcnt(5)
    v_mfma_f32_32x32x16_bf16 v[156:171], a[60:63], v[48:51], v[156:171]
    ds_read_b64_tr_b16 a[60:61], v18 offset:57344
    ds_read_b64_tr_b16 a[62:63], v18 offset:58368
    v_mfma_f32_32x32x16_bf16 v[172:187], a[64:67], v[48:51], v[172:187]
    ds_read_b64_tr_b16 a[64:65], v19 offset:57344
    ds_read_b64_tr_b16 a[66:67], v19 offset:58368
    s_waitcnt lgkmcnt(4)
    v_mfma_f32_32x32x16_bf16 v[124:139], a[52:55], v[52:55], v[124:139]
    ds_read_b128 v[44:47], v11 offset:32768
    ds_read_b64_tr_b16 a[52:53], v16 offset:61440
    ds_read_b64_tr_b16 a[54:55], v16 offset:62464
    v_mfma_f32_32x32x16_bf16 v[140:155], a[56:59], v[52:55], v[140:155]
    ds_read_b64_tr_b16 a[56:57], v17 offset:61440
    ds_read_b64_tr_b16 a[58:59], v17 offset:62464
    s_waitcnt lgkmcnt(5)
    v_mfma_f32_32x32x16_bf16 v[156:171], a[60:63], v[52:55], v[156:171]
    ds_read_b64_tr_b16 a[60:61], v18 offset:61440
    ds_read_b64_tr_b16 a[62:63], v18 offset:62464
    v_mfma_f32_32x32x16_bf16 v[172:187], a[64:67], v[52:55], v[172:187]
    ds_read_b64_tr_b16 a[64:65], v19 offset:61440
    ds_read_b64_tr_b16 a[66:67], v19 offset:62464
    s_waitcnt lgkmcnt(4)
    v_mfma_f32_32x32x16_bf16 v[124:139], a[52:55], v[44:47], v[124:139]
    s_barrier
    ds_read_b128 v[48:51], v12 offset:0
    ds_read_b64_tr_b16 a[52:53], v20 offset:16384
    ds_read_b64_tr_b16 a[54:55], v20 offset:17408
    v_mfma_f32_32x32x16_bf16 v[140:155], a[56:59], v[44:47], v[140:155]
    ds_read_b64_tr_b16 a[56:57], v21 offset:16384
    ds_read_b64_tr_b16 a[58:59], v21 offset:17408
    s_waitcnt lgkmcnt(5)
    v_mfma_f32_32x32x16_bf16 v[156:171], a[60:63], v[44:47], v[156:171]
    ds_read_b64_tr_b16 a[60:61], v22 offset:16384
    ds_read_b64_tr_b16 a[62:63], v22 offset:17408
    v_mfma_f32_32x32x16_bf16 v[172:187], a[64:67], v[44:47], v[172:187]
    ds_read_b64_tr_b16 a[64:65], v23 offset:16384
    ds_read_b64_tr_b16 a[66:67], v23 offset:17408
    s_waitcnt lgkmcnt(4)
    v_mfma_f32_32x32x16_bf16 v[124:139], a[52:55], v[48:51], v[124:139]
    ds_read_b128 v[52:55], v13 offset:0
    ds_read_b64_tr_b16 a[52:53], v20 offset:20480
    ds_read_b64_tr_b16 a[54:55], v20 offset:21504
    v_mfma_f32_32x32x16_bf16 v[140:155], a[56:59], v[48:51], v[140:155]
    ds_read_b64_tr_b16 a[56:57], v21 offset:20480
    ds_read_b64_tr_b16 a[58:59], v21 offset:21504
    s_waitcnt lgkmcnt(5)
    v_mfma_f32_32x32x16_bf16 v[156:171], a[60:63], v[48:51], v[156:171]
    ds_read_b64_tr_b16 a[60:61], v22 offset:20480
    ds_read_b64_tr_b16 a[62:63], v22 offset:21504
    v_mfma_f32_32x32x16_bf16 v[172:187], a[64:67], v[48:51], v[172:187]
    ds_read_b64_tr_b16 a[64:65], v23 offset:20480
    ds_read_b64_tr_b16 a[66:67], v23 offset:21504
    s_waitcnt lgkmcnt(4)
    v_mfma_f32_32x32x16_bf16 v[124:139], a[52:55], v[52:55], v[124:139]
    ds_read_b128 v[44:47], v14 offset:0
    ds_read_b64_tr_b16 a[52:53], v20 offset:24576
    ds_read_b64_tr_b16 a[54:55], v20 offset:25600
    v_mfma_f32_32x32x16_bf16 v[140:155], a[56:59], v[52:55], v[140:155]
    ds_read_b64_tr_b16 a[56:57], v21 offset:24576
    ds_read_b64_tr_b16 a[58:59], v21 offset:25600
    s_waitcnt lgkmcnt(5)
    v_mfma_f32_32x32x16_bf16 v[156:171], a[60:63], v[52:55], v[156:171]
    ds_read_b64_tr_b16 a[60:61], v22 offset:24576
    ds_read_b64_tr_b16 a[62:63], v22 offset:25600
    v_mfma_f32_32x32x16_bf16 v[172:187], a[64:67], v[52:55], v[172:187]
    ds_read_b64_tr_b16 a[64:65], v23 offset:24576
    ds_read_b64_tr_b16 a[66:67], v23 offset:25600
    s_waitcnt lgkmcnt(4)
    v_mfma_f32_32x32x16_bf16 v[124:139], a[52:55], v[44:47], v[124:139]
    ds_read_b128 v[48:51], v15 offset:0
    ds_read_b64_tr_b16 a[52:53], v20 offset:28672
    ds_read_b64_tr_b16 a[54:55], v20 offset:29696
    v_mfma_f32_32x32x16_bf16 v[140:155], a[56:59], v[44:47], v[140:155]
    ds_read_b64_tr_b16 a[56:57], v21 offset:28672
    ds_read_b64_tr_b16 a[58:59], v21 offset:29696
    s_waitcnt lgkmcnt(5)
    v_mfma_f32_32x32x16_bf16 v[156:171], a[60:63], v[44:47], v[156:171]
    ds_read_b64_tr_b16 a[60:61], v22 offset:28672
    ds_read_b64_tr_b16 a[62:63], v22 offset:29696
    v_mfma_f32_32x32x16_bf16 v[172:187], a[64:67], v[44:47], v[172:187]
    ds_read_b64_tr_b16 a[64:65], v23 offset:28672
    ds_read_b64_tr_b16 a[66:67], v23 offset:29696
    s_waitcnt lgkmcnt(4)
    v_mfma_f32_32x32x16_bf16 v[124:139], a[52:55], v[48:51], v[124:139]
    s_barrier
    ds_read_b128 v[52:55], v8 offset:0
    ds_read_b64_tr_b16 a[52:53], v16 offset:16384
    ds_read_b64_tr_b16 a[54:55], v16 offset:17408
    v_mfma_f32_32x32x16_bf16 v[140:155], a[56:59], v[48:51], v[140:155]
    ds_read_b64_tr_b16 a[56:57], v17 offset:16384
    ds_read_b64_tr_b16 a[58:59], v17 offset:17408
    s_waitcnt lgkmcnt(5)
    v_mfma_f32_32x32x16_bf16 v[156:171], a[60:63], v[48:51], v[156:171]
    ds_read_b64_tr_b16 a[60:61], v18 offset:16384
    ds_read_b64_tr_b16 a[62:63], v18 offset:17408
    v_mfma_f32_32x32x16_bf16 v[172:187], a[64:67], v[48:51], v[172:187]
    ds_read_b64_tr_b16 a[64:65], v19 offset:16384
    ds_read_b64_tr_b16 a[66:67], v19 offset:17408
    s_waitcnt lgkmcnt(4)
    v_mfma_f32_32x32x16_bf16 v[124:139], a[52:55], v[52:55], v[124:139]
    ds_read_b128 v[44:47], v9 offset:0
    ds_read_b64_tr_b16 a[52:53], v16 offset:20480
    ds_read_b64_tr_b16 a[54:55], v16 offset:21504
    v_mfma_f32_32x32x16_bf16 v[140:155], a[56:59], v[52:55], v[140:155]
    ds_read_b64_tr_b16 a[56:57], v17 offset:20480
    ds_read_b64_tr_b16 a[58:59], v17 offset:21504
    s_waitcnt lgkmcnt(5)
    v_mfma_f32_32x32x16_bf16 v[156:171], a[60:63], v[52:55], v[156:171]
    ds_read_b64_tr_b16 a[60:61], v18 offset:20480
    ds_read_b64_tr_b16 a[62:63], v18 offset:21504
    v_mfma_f32_32x32x16_bf16 v[172:187], a[64:67], v[52:55], v[172:187]
    ds_read_b64_tr_b16 a[64:65], v19 offset:20480
    ds_read_b64_tr_b16 a[66:67], v19 offset:21504
    s_waitcnt lgkmcnt(4)
    v_mfma_f32_32x32x16_bf16 v[124:139], a[52:55], v[44:47], v[124:139]
    ds_read_b128 v[48:51], v10 offset:0
    ds_read_b64_tr_b16 a[52:53], v16 offset:24576
    ds_read_b64_tr_b16 a[54:55], v16 offset:25600
    v_mfma_f32_32x32x16_bf16 v[140:155], a[56:59], v[44:47], v[140:155]
    ds_read_b64_tr_b16 a[56:57], v17 offset:24576
    ds_read_b64_tr_b16 a[58:59], v17 offset:25600
    s_waitcnt lgkmcnt(5)
    v_mfma_f32_32x32x16_bf16 v[156:171], a[60:63], v[44:47], v[156:171]
    ds_read_b64_tr_b16 a[60:61], v18 offset:24576
    ds_read_b64_tr_b16 a[62:63], v18 offset:25600
    v_mfma_f32_32x32x16_bf16 v[172:187], a[64:67], v[44:47], v[172:187]
    ds_read_b64_tr_b16 a[64:65], v19 offset:24576
    ds_read_b64_tr_b16 a[66:67], v19 offset:25600
    s_waitcnt lgkmcnt(4)
    v_mfma_f32_32x32x16_bf16 v[124:139], a[52:55], v[48:51], v[124:139]
    ds_read_b128 v[52:55], v11 offset:0
    ds_read_b64_tr_b16 a[52:53], v16 offset:28672
    ds_read_b64_tr_b16 a[54:55], v16 offset:29696
    v_mfma_f32_32x32x16_bf16 v[140:155], a[56:59], v[48:51], v[140:155]
    ds_read_b64_tr_b16 a[56:57], v17 offset:28672
    ds_read_b64_tr_b16 a[58:59], v17 offset:29696
    s_waitcnt lgkmcnt(5)
    v_mfma_f32_32x32x16_bf16 v[156:171], a[60:63], v[48:51], v[156:171]
    ds_read_b64_tr_b16 a[60:61], v18 offset:28672
    ds_read_b64_tr_b16 a[62:63], v18 offset:29696
    v_mfma_f32_32x32x16_bf16 v[172:187], a[64:67], v[48:51], v[172:187]
    ds_read_b64_tr_b16 a[64:65], v19 offset:28672
    ds_read_b64_tr_b16 a[66:67], v19 offset:29696
    s_waitcnt lgkmcnt(4)
    v_mfma_f32_32x32x16_bf16 v[124:139], a[52:55], v[52:55], v[124:139]
    s_barrier
    ds_read_b128 v[44:47], v8 offset:32768
    ds_read_b64_tr_b16 a[52:53], v16 offset:49152
    ds_read_b64_tr_b16 a[54:55], v16 offset:50176
    v_mfma_f32_32x32x16_bf16 v[140:155], a[56:59], v[52:55], v[140:155]
    ds_read_b64_tr_b16 a[56:57], v17 offset:49152
    ds_read_b64_tr_b16 a[58:59], v17 offset:50176
    s_waitcnt lgkmcnt(5)
    v_mfma_f32_32x32x16_bf16 v[156:171], a[60:63], v[52:55], v[156:171]
    ds_read_b64_tr_b16 a[60:61], v18 offset:49152
    ds_read_b64_tr_b16 a[62:63], v18 offset:50176
    v_mfma_f32_32x32x16_bf16 v[172:187], a[64:67], v[52:55], v[172:187]
    ds_read_b64_tr_b16 a[64:65], v19 offset:49152
    ds_read_b64_tr_b16 a[66:67], v19 offset:50176
    s_waitcnt lgkmcnt(4)
    v_mfma_f32_32x32x16_bf16 v[124:139], a[52:55], v[44:47], v[124:139]
    ds_read_b128 v[48:51], v9 offset:32768
    ds_read_b64_tr_b16 a[52:53], v16 offset:53248
    ds_read_b64_tr_b16 a[54:55], v16 offset:54272
    v_mfma_f32_32x32x16_bf16 v[140:155], a[56:59], v[44:47], v[140:155]
    ds_read_b64_tr_b16 a[56:57], v17 offset:53248
    ds_read_b64_tr_b16 a[58:59], v17 offset:54272
    s_waitcnt lgkmcnt(5)
    v_mfma_f32_32x32x16_bf16 v[156:171], a[60:63], v[44:47], v[156:171]
    ds_read_b64_tr_b16 a[60:61], v18 offset:53248
    ds_read_b64_tr_b16 a[62:63], v18 offset:54272
    v_mfma_f32_32x32x16_bf16 v[172:187], a[64:67], v[44:47], v[172:187]
    ds_read_b64_tr_b16 a[64:65], v19 offset:53248
    ds_read_b64_tr_b16 a[66:67], v19 offset:54272
    s_waitcnt lgkmcnt(4)
    v_mfma_f32_32x32x16_bf16 v[124:139], a[52:55], v[48:51], v[124:139]
    global_load_dword v41, v2, s[16:17] sc0 sc1
    ds_read_b128 v[52:55], v10 offset:32768
    ds_read_b64_tr_b16 a[52:53], v16 offset:57344
    ds_read_b64_tr_b16 a[54:55], v16 offset:58368
    v_mfma_f32_32x32x16_bf16 v[140:155], a[56:59], v[48:51], v[140:155]
    ds_read_b64_tr_b16 a[56:57], v17 offset:57344
    ds_read_b64_tr_b16 a[58:59], v17 offset:58368
    s_waitcnt lgkmcnt(5)
    v_mfma_f32_32x32x16_bf16 v[156:171], a[60:63], v[48:51], v[156:171]
    ds_read_b64_tr_b16 a[60:61], v18 offset:57344
    ds_read_b64_tr_b16 a[62:63], v18 offset:58368
    v_mfma_f32_32x32x16_bf16 v[172:187], a[64:67], v[48:51], v[172:187]
    ds_read_b64_tr_b16 a[64:65], v19 offset:57344
    ds_read_b64_tr_b16 a[66:67], v19 offset:58368
    s_waitcnt lgkmcnt(4)
    v_mfma_f32_32x32x16_bf16 v[124:139], a[52:55], v[52:55], v[124:139]
    ds_read_b128 v[44:47], v11 offset:32768
    ds_read_b64_tr_b16 a[52:53], v16 offset:61440
    ds_read_b64_tr_b16 a[54:55], v16 offset:62464
    v_mfma_f32_32x32x16_bf16 v[140:155], a[56:59], v[52:55], v[140:155]
    ds_read_b64_tr_b16 a[56:57], v17 offset:61440
    ds_read_b64_tr_b16 a[58:59], v17 offset:62464
    s_waitcnt lgkmcnt(5)
    v_mfma_f32_32x32x16_bf16 v[156:171], a[60:63], v[52:55], v[156:171]
    ds_read_b64_tr_b16 a[60:61], v18 offset:61440
    ds_read_b64_tr_b16 a[62:63], v18 offset:62464
    v_mfma_f32_32x32x16_bf16 v[172:187], a[64:67], v[52:55], v[172:187]
    ds_read_b64_tr_b16 a[64:65], v19 offset:61440
    ds_read_b64_tr_b16 a[66:67], v19 offset:62464
    s_waitcnt lgkmcnt(4)
    v_mfma_f32_32x32x16_bf16 v[124:139], a[52:55], v[44:47], v[124:139]
    s_barrier
    ds_read_b128 v[48:51], v12 offset:0
    ds_read_b64_tr_b16 a[52:53], v20 offset:16384
    ds_read_b64_tr_b16 a[54:55], v20 offset:17408
    v_mfma_f32_32x32x16_bf16 v[140:155], a[56:59], v[44:47], v[140:155]
    ds_read_b64_tr_b16 a[56:57], v21 offset:16384
    ds_read_b64_tr_b16 a[58:59], v21 offset:17408
    s_waitcnt lgkmcnt(5)
    v_mfma_f32_32x32x16_bf16 v[156:171], a[60:63], v[44:47], v[156:171]
    ds_read_b64_tr_b16 a[60:61], v22 offset:16384
    ds_read_b64_tr_b16 a[62:63], v22 offset:17408
    v_mfma_f32_32x32x16_bf16 v[172:187], a[64:67], v[44:47], v[172:187]
    ds_read_b64_tr_b16 a[64:65], v23 offset:16384
    ds_read_b64_tr_b16 a[66:67], v23 offset:17408
    s_waitcnt lgkmcnt(4)
    v_mfma_f32_32x32x16_bf16 v[124:139], a[52:55], v[48:51], v[124:139]
    ds_read_b128 v[52:55], v13 offset:0
    ds_read_b64_tr_b16 a[52:53], v20 offset:20480
    ds_read_b64_tr_b16 a[54:55], v20 offset:21504
    v_mfma_f32_32x32x16_bf16 v[140:155], a[56:59], v[48:51], v[140:155]
    ds_read_b64_tr_b16 a[56:57], v21 offset:20480
    ds_read_b64_tr_b16 a[58:59], v21 offset:21504
    s_waitcnt lgkmcnt(5)
    v_mfma_f32_32x32x16_bf16 v[156:171], a[60:63], v[48:51], v[156:171]
    ds_read_b64_tr_b16 a[60:61], v22 offset:20480
    ds_read_b64_tr_b16 a[62:63], v22 offset:21504
    v_mfma_f32_32x32x16_bf16 v[172:187], a[64:67], v[48:51], v[172:187]
    ds_read_b64_tr_b16 a[64:65], v23 offset:20480
    ds_read_b64_tr_b16 a[66:67], v23 offset:21504
    s_waitcnt lgkmcnt(4)
    v_mfma_f32_32x32x16_bf16 v[124:139], a[52:55], v[52:55], v[124:139]
    ds_read_b128 v[44:47], v14 offset:0
    ds_read_b64_tr_b16 a[52:53], v20 offset:24576
    ds_read_b64_tr_b16 a[54:55], v20 offset:25600
    v_mfma_f32_32x32x16_bf16 v[140:155], a[56:59], v[52:55], v[140:155]
    ds_read_b64_tr_b16 a[56:57], v21 offset:24576
    ds_read_b64_tr_b16 a[58:59], v21 offset:25600
    s_waitcnt lgkmcnt(5)
    v_mfma_f32_32x32x16_bf16 v[156:171], a[60:63], v[52:55], v[156:171]
    ds_read_b64_tr_b16 a[60:61], v22 offset:24576
    ds_read_b64_tr_b16 a[62:63], v22 offset:25600
    v_mfma_f32_32x32x16_bf16 v[172:187], a[64:67], v[52:55], v[172:187]
    ds_read_b64_tr_b16 a[64:65], v23 offset:24576
    ds_read_b64_tr_b16 a[66:67], v23 offset:25600
    s_waitcnt lgkmcnt(4)
    v_mfma_f32_32x32x16_bf16 v[124:139], a[52:55], v[44:47], v[124:139]
    ds_read_b128 v[48:51], v15 offset:0
    ds_read_b64_tr_b16 a[52:53], v20 offset:28672
    ds_read_b64_tr_b16 a[54:55], v20 offset:29696
    v_mfma_f32_32x32x16_bf16 v[140:155], a[56:59], v[44:47], v[140:155]
    ds_read_b64_tr_b16 a[56:57], v21 offset:28672
    ds_read_b64_tr_b16 a[58:59], v21 offset:29696
    s_waitcnt lgkmcnt(5)
    v_mfma_f32_32x32x16_bf16 v[156:171], a[60:63], v[44:47], v[156:171]
    ds_read_b64_tr_b16 a[60:61], v22 offset:28672
    ds_read_b64_tr_b16 a[62:63], v22 offset:29696
    v_mfma_f32_32x32x16_bf16 v[172:187], a[64:67], v[44:47], v[172:187]
    ds_read_b64_tr_b16 a[64:65], v23 offset:28672
    ds_read_b64_tr_b16 a[66:67], v23 offset:29696
    s_waitcnt lgkmcnt(4)
    v_mfma_f32_32x32x16_bf16 v[124:139], a[52:55], v[48:51], v[124:139]
    s_barrier
    ds_read_b128 v[52:55], v8 offset:0
    ds_read_b64_tr_b16 a[52:53], v16 offset:16384
    ds_read_b64_tr_b16 a[54:55], v16 offset:17408
    v_mfma_f32_32x32x16_bf16 v[140:155], a[56:59], v[48:51], v[140:155]
    ds_read_b64_tr_b16 a[56:57], v17 offset:16384
    ds_read_b64_tr_b16 a[58:59], v17 offset:17408
    s_waitcnt lgkmcnt(5)
    v_mfma_f32_32x32x16_bf16 v[156:171], a[60:63], v[48:51], v[156:171]
    ds_read_b64_tr_b16 a[60:61], v18 offset:16384
    ds_read_b64_tr_b16 a[62:63], v18 offset:17408
    v_mfma_f32_32x32x16_bf16 v[172:187], a[64:67], v[48:51], v[172:187]
    ds_read_b64_tr_b16 a[64:65], v19 offset:16384
    ds_read_b64_tr_b16 a[66:67], v19 offset:17408
    s_waitcnt lgkmcnt(4)
    v_mfma_f32_32x32x16_bf16 v[124:139], a[52:55], v[52:55], v[124:139]
    ds_read_b128 v[44:47], v9 offset:0
    ds_read_b64_tr_b16 a[52:53], v16 offset:20480
    ds_read_b64_tr_b16 a[54:55], v16 offset:21504
    v_mfma_f32_32x32x16_bf16 v[140:155], a[56:59], v[52:55], v[140:155]
    ds_read_b64_tr_b16 a[56:57], v17 offset:20480
    ds_read_b64_tr_b16 a[58:59], v17 offset:21504
    s_waitcnt lgkmcnt(5)
    v_mfma_f32_32x32x16_bf16 v[156:171], a[60:63], v[52:55], v[156:171]
    ds_read_b64_tr_b16 a[60:61], v18 offset:20480
    ds_read_b64_tr_b16 a[62:63], v18 offset:21504
    v_mfma_f32_32x32x16_bf16 v[172:187], a[64:67], v[52:55], v[172:187]
    ds_read_b64_tr_b16 a[64:65], v19 offset:20480
    ds_read_b64_tr_b16 a[66:67], v19 offset:21504
    s_waitcnt lgkmcnt(4)
    v_mfma_f32_32x32x16_bf16 v[124:139], a[52:55], v[44:47], v[124:139]
    ds_read_b128 v[48:51], v10 offset:0
    ds_read_b64_tr_b16 a[52:53], v16 offset:24576
    ds_read_b64_tr_b16 a[54:55], v16 offset:25600
    v_mfma_f32_32x32x16_bf16 v[140:155], a[56:59], v[44:47], v[140:155]
    ds_read_b64_tr_b16 a[56:57], v17 offset:24576
    ds_read_b64_tr_b16 a[58:59], v17 offset:25600
    s_waitcnt lgkmcnt(5)
    v_mfma_f32_32x32x16_bf16 v[156:171], a[60:63], v[44:47], v[156:171]
    ds_read_b64_tr_b16 a[60:61], v18 offset:24576
    ds_read_b64_tr_b16 a[62:63], v18 offset:25600
    v_mfma_f32_32x32x16_bf16 v[172:187], a[64:67], v[44:47], v[172:187]
    ds_read_b64_tr_b16 a[64:65], v19 offset:24576
    ds_read_b64_tr_b16 a[66:67], v19 offset:25600
    s_waitcnt lgkmcnt(4)
    v_mfma_f32_32x32x16_bf16 v[124:139], a[52:55], v[48:51], v[124:139]
    ds_read_b128 v[52:55], v11 offset:0
    ds_read_b64_tr_b16 a[52:53], v16 offset:28672
    ds_read_b64_tr_b16 a[54:55], v16 offset:29696
    v_mfma_f32_32x32x16_bf16 v[140:155], a[56:59], v[48:51], v[140:155]
    ds_read_b64_tr_b16 a[56:57], v17 offset:28672
    ds_read_b64_tr_b16 a[58:59], v17 offset:29696
    s_waitcnt lgkmcnt(5)
    v_mfma_f32_32x32x16_bf16 v[156:171], a[60:63], v[48:51], v[156:171]
    ds_read_b64_tr_b16 a[60:61], v18 offset:28672
    ds_read_b64_tr_b16 a[62:63], v18 offset:29696
    v_mfma_f32_32x32x16_bf16 v[172:187], a[64:67], v[48:51], v[172:187]
    ds_read_b64_tr_b16 a[64:65], v19 offset:28672
    ds_read_b64_tr_b16 a[66:67], v19 offset:29696
    s_waitcnt lgkmcnt(4)
    v_mfma_f32_32x32x16_bf16 v[124:139], a[52:55], v[52:55], v[124:139]
    s_barrier
    ds_read_b128 v[44:47], v8 offset:32768
    ds_read_b64_tr_b16 a[52:53], v16 offset:49152
    ds_read_b64_tr_b16 a[54:55], v16 offset:50176
    v_mfma_f32_32x32x16_bf16 v[140:155], a[56:59], v[52:55], v[140:155]
    ds_read_b64_tr_b16 a[56:57], v17 offset:49152
    ds_read_b64_tr_b16 a[58:59], v17 offset:50176
    s_waitcnt lgkmcnt(5)
    v_mfma_f32_32x32x16_bf16 v[156:171], a[60:63], v[52:55], v[156:171]
    ds_read_b64_tr_b16 a[60:61], v18 offset:49152
    ds_read_b64_tr_b16 a[62:63], v18 offset:50176
    v_mfma_f32_32x32x16_bf16 v[172:187], a[64:67], v[52:55], v[172:187]
    ds_read_b64_tr_b16 a[64:65], v19 offset:49152
    ds_read_b64_tr_b16 a[66:67], v19 offset:50176
    s_waitcnt lgkmcnt(4)
    v_mfma_f32_32x32x16_bf16 v[124:139], a[52:55], v[44:47], v[124:139]
    ds_read_b128 v[48:51], v9 offset:32768
    ds_read_b64_tr_b16 a[52:53], v16 offset:53248
    ds_read_b64_tr_b16 a[54:55], v16 offset:54272
    v_mfma_f32_32x32x16_bf16 v[140:155], a[56:59], v[44:47], v[140:155]
    ds_read_b64_tr_b16 a[56:57], v17 offset:53248
    ds_read_b64_tr_b16 a[58:59], v17 offset:54272
    s_waitcnt lgkmcnt(5)
    v_mfma_f32_32x32x16_bf16 v[156:171], a[60:63], v[44:47], v[156:171]
    ds_read_b64_tr_b16 a[60:61], v18 offset:53248
    ds_read_b64_tr_b16 a[62:63], v18 offset:54272
    v_mfma_f32_32x32x16_bf16 v[172:187], a[64:67], v[44:47], v[172:187]
    ds_read_b64_tr_b16 a[64:65], v19 offset:53248
    ds_read_b64_tr_b16 a[66:67], v19 offset:54272
    s_waitcnt lgkmcnt(4)
    v_mfma_f32_32x32x16_bf16 v[124:139], a[52:55], v[48:51], v[124:139]
    ds_read_b128 v[52:55], v10 offset:32768
    ds_read_b64_tr_b16 a[52:53], v16 offset:57344
    ds_read_b64_tr_b16 a[54:55], v16 offset:58368
    v_mfma_f32_32x32x16_bf16 v[140:155], a[56:59], v[48:51], v[140:155]
    ds_read_b64_tr_b16 a[56:57], v17 offset:57344
    ds_read_b64_tr_b16 a[58:59], v17 offset:58368
    s_waitcnt lgkmcnt(5)
    v_mfma_f32_32x32x16_bf16 v[156:171], a[60:63], v[48:51], v[156:171]
    ds_read_b64_tr_b16 a[60:61], v18 offset:57344
    ds_read_b64_tr_b16 a[62:63], v18 offset:58368
    v_mfma_f32_32x32x16_bf16 v[172:187], a[64:67], v[48:51], v[172:187]
    ds_read_b64_tr_b16 a[64:65], v19 offset:57344
    ds_read_b64_tr_b16 a[66:67], v19 offset:58368
    s_waitcnt lgkmcnt(4)
    v_mfma_f32_32x32x16_bf16 v[124:139], a[52:55], v[52:55], v[124:139]
    ds_read_b128 v[44:47], v11 offset:32768
    ds_read_b64_tr_b16 a[52:53], v16 offset:61440
    ds_read_b64_tr_b16 a[54:55], v16 offset:62464
    v_mfma_f32_32x32x16_bf16 v[140:155], a[56:59], v[52:55], v[140:155]
    ds_read_b64_tr_b16 a[56:57], v17 offset:61440
    ds_read_b64_tr_b16 a[58:59], v17 offset:62464
    s_waitcnt lgkmcnt(5)
    v_mfma_f32_32x32x16_bf16 v[156:171], a[60:63], v[52:55], v[156:171]
    ds_read_b64_tr_b16 a[60:61], v18 offset:61440
    ds_read_b64_tr_b16 a[62:63], v18 offset:62464
    v_mfma_f32_32x32x16_bf16 v[172:187], a[64:67], v[52:55], v[172:187]
    ds_read_b64_tr_b16 a[64:65], v19 offset:61440
    ds_read_b64_tr_b16 a[66:67], v19 offset:62464
    s_waitcnt lgkmcnt(4)
    v_mfma_f32_32x32x16_bf16 v[124:139], a[52:55], v[44:47], v[124:139]
    s_barrier
    ds_read_b128 v[48:51], v12 offset:0
    ds_read_b64_tr_b16 a[52:53], v20 offset:16384
    ds_read_b64_tr_b16 a[54:55], v20 offset:17408
    v_mfma_f32_32x32x16_bf16 v[140:155], a[56:59], v[44:47], v[140:155]
    ds_read_b64_tr_b16 a[56:57], v21 offset:16384
    ds_read_b64_tr_b16 a[58:59], v21 offset:17408
    s_waitcnt lgkmcnt(5)
    v_mfma_f32_32x32x16_bf16 v[156:171], a[60:63], v[44:47], v[156:171]
    ds_read_b64_tr_b16 a[60:61], v22 offset:16384
    ds_read_b64_tr_b16 a[62:63], v22 offset:17408
    v_mfma_f32_32x32x16_bf16 v[172:187], a[64:67], v[44:47], v[172:187]
    ds_read_b64_tr_b16 a[64:65], v23 offset:16384
    ds_read_b64_tr_b16 a[66:67], v23 offset:17408
    s_waitcnt lgkmcnt(4)
    v_mfma_f32_32x32x16_bf16 v[124:139], a[52:55], v[48:51], v[124:139]
    ds_read_b128 v[52:55], v13 offset:0
    ds_read_b64_tr_b16 a[52:53], v20 offset:20480
    ds_read_b64_tr_b16 a[54:55], v20 offset:21504
    v_mfma_f32_32x32x16_bf16 v[140:155], a[56:59], v[48:51], v[140:155]
    ds_read_b64_tr_b16 a[56:57], v21 offset:20480
    ds_read_b64_tr_b16 a[58:59], v21 offset:21504
    s_waitcnt lgkmcnt(5)
    v_mfma_f32_32x32x16_bf16 v[156:171], a[60:63], v[48:51], v[156:171]
    ds_read_b64_tr_b16 a[60:61], v22 offset:20480
    ds_read_b64_tr_b16 a[62:63], v22 offset:21504
    v_mfma_f32_32x32x16_bf16 v[172:187], a[64:67], v[48:51], v[172:187]
    ds_read_b64_tr_b16 a[64:65], v23 offset:20480
    ds_read_b64_tr_b16 a[66:67], v23 offset:21504
    s_waitcnt lgkmcnt(4)
    v_mfma_f32_32x32x16_bf16 v[124:139], a[52:55], v[52:55], v[124:139]
    s_waitcnt vmcnt(0)
    v_readfirstlane_b32 s70, v41
    s_nop 3
    s_cmp_eq_u32 s70, 0
    s_cbranch_scc1 L_nspin
L_nspin_back:
    s_or_b32 s65, s70, s26
    s_lshl_b32 s66, s22, 2
    s_add_u32 s66, s66, s79
    v_mov_b32 v3, s66
    v_mov_b32 v4, s65
    s_mov_b64 exec, 1
    global_store_dword v3, v4, s[18:19] sc1
    s_mov_b64 exec, -1
    ds_read_b128 v[44:47], v14 offset:0
    ds_read_b64_tr_b16 a[52:53], v20 offset:24576
    ds_read_b64_tr_b16 a[54:55], v20 offset:25600
    v_mfma_f32_32x32x16_bf16 v[140:155], a[56:59], v[52:55], v[140:155]
    ds_read_b64_tr_b16 a[56:57], v21 offset:24576
    ds_read_b64_tr_b16 a[58:59], v21 offset:25600
    s_waitcnt lgkmcnt(5)
    v_mfma_f32_32x32x16_bf16 v[156:171], a[60:63], v[52:55], v[156:171]
    ds_read_b64_tr_b16 a[60:61], v22 offset:24576
    ds_read_b64_tr_b16 a[62:63], v22 offset:25600
    v_mfma_f32_32x32x16_bf16 v[172:187], a[64:67], v[52:55], v[172:187]
    ds_read_b64_tr_b16 a[64:65], v23 offset:24576
    ds_read_b64_tr_b16 a[66:67], v23 offset:25600
    s_waitcnt lgkmcnt(4)
    v_mfma_f32_32x32x16_bf16 v[124:139], a[52:55], v[44:47], v[124:139]
    ds_read_b128 v[48:51], v15 offset:0
    ds_read_b64_tr_b16 a[52:53], v20 offset:28672
    ds_read_b64_tr_b16 a[54:55], v20 offset:29696
    v_mfma_f32_32x32x16_bf16 v[140:155], a[56:59], v[44:47], v[140:155]
    ds_read_b64_tr_b16 a[56:57], v21 offset:28672
    ds_read_b64_tr_b16 a[58:59], v21 offset:29696
    s_waitcnt lgkmcnt(5)
    v_mfma_f32_32x32x16_bf16 v[156:171], a[60:63], v[44:47], v[156:171]
    ds_read_b64_tr_b16 a[60:61], v22 offset:28672
    ds_read_b64_tr_b16 a[62:63], v22 offset:29696
    v_mfma_f32_32x32x16_bf16 v[172:187], a[64:67], v[44:47], v[172:187]
    ds_read_b64_tr_b16 a[64:65], v23 offset:28672
    ds_read_b64_tr_b16 a[66:67], v23 offset:29696
    s_waitcnt lgkmcnt(4)
    v_mfma_f32_32x32x16_bf16 v[124:139], a[52:55], v[48:51], v[124:139]
    s_barrier
    ds_read_b128 v[52:55], v8 offset:0
    ds_read_b64_tr_b16 a[52:53], v16 offset:16384
    ds_read_b64_tr_b16 a[54:55], v16 offset:17408
    v_mfma_f32_32x32x16_bf16 v[140:155], a[56:59], v[48:51], v[140:155]
    ds_read_b64_tr_b16 a[56:57], v17 offset:16384
    ds_read_b64_tr_b16 a[58:59], v17 offset:17408
    s_waitcnt lgkmcnt(5)
    v_mfma_f32_32x32x16_bf16 v[156:171], a[60:63], v[48:51], v[156:171]
    ds_read_b64_tr_b16 a[60:61], v18 offset:16384
    ds_read_b64_tr_b16 a[62:63], v18 offset:17408
    v_mfma_f32_32x32x16_bf16 v[172:187], a[64:67], v[48:51], v[172:187]
    ds_read_b64_tr_b16 a[64:65], v19 offset:16384
    ds_read_b64_tr_b16 a[66:67], v19 offset:17408
    s_waitcnt lgkmcnt(4)
    v_mfma_f32_32x32x16_bf16 v[124:139], a[52:55], v[52:55], v[124:139]
    ds_read_b128 v[44:47], v9 offset:0
    ds_read_b64_tr_b16 a[52:53], v16 offset:20480
    ds_read_b64_tr_b16 a[54:55], v16 offset:21504
    v_mfma_f32_32x32x16_bf16 v[140:155], a[56:59], v[52:55], v[140:155]
    ds_read_b64_tr_b16 a[56:57], v17 offset:20480
    ds_read_b64_tr_b16 a[58:59], v17 offset:21504
    s_waitcnt lgkmcnt(5)
    v_mfma_f32_32x32x16_bf16 v[156:171], a[60:63], v[52:55], v[156:171]
    ds_read_b64_tr_b16 a[60:61], v18 offset:20480
    ds_read_b64_tr_b16 a[62:63], v18 offset:21504
    v_mfma_f32_32x32x16_bf16 v[172:187], a[64:67], v[52:55], v[172:187]
    ds_read_b64_tr_b16 a[64:65], v19 offset:20480
    ds_read_b64_tr_b16 a[66:67], v19 offset:21504
    s_waitcnt lgkmcnt(4)
    v_mfma_f32_32x32x16_bf16 v[124:139], a[52:55], v[44:47], v[124:139]
    ds_read_b128 v[48:51], v10 offset:0
    ds_read_b64_tr_b16 a[52:53], v16 offset:24576
    ds_read_b64_tr_b16 a[54:55], v16 offset:25600
    v_mfma_f32_32x32x16_bf16 v[140:155], a[56:59], v[44:47], v[140:155]
    ds_read_b64_tr_b16 a[56:57], v17 offset:24576
    ds_read_b64_tr_b16 a[58:59], v17 offset:25600
    s_waitcnt lgkmcnt(5)
    v_mfma_f32_32x32x16_bf16 v[156:171], a[60:63], v[44:47], v[156:171]
    ds_read_b64_tr_b16 a[60:61], v18 offset:24576
    ds_read_b64_tr_b16 a[62:63], v18 offset:25600
    v_mfma_f32_32x32x16_bf16 v[172:187], a[64:67], v[44:47], v[172:187]
    ds_read_b64_tr_b16 a[64:65], v19 offset:24576
    ds_read_b64_tr_b16 a[66:67], v19 offset:25600
    s_waitcnt lgkmcnt(4)
    v_mfma_f32_32x32x16_bf16 v[124:139], a[52:55], v[48:51], v[124:139]
    ds_read_b128 v[52:55], v11 offset:0
    ds_read_b64_tr_b16 a[52:53], v16 offset:28672
    ds_read_b64_tr_b16 a[54:55], v16 offset:29696
    v_mfma_f32_32x32x16_bf16 v[140:155], a[56:59], v[48:51], v[140:155]
    ds_read_b64_tr_b16 a[56:57], v17 offset:28672
    ds_read_b64_tr_b16 a[58:59], v17 offset:29696
    s_waitcnt lgkmcnt(5)
    v_mfma_f32_32x32x16_bf16 v[156:171], a[60:63], v[48:51], v[156:171]
    ds_read_b64_tr_b16 a[60:61], v18 offset:28672
    ds_read_b64_tr_b16 a[62:63], v18 offset:29696
    v_mfma_f32_32x32x16_bf16 v[172:187], a[64:67], v[48:51], v[172:187]
    ds_read_b64_tr_b16 a[64:65], v19 offset:28672
    ds_read_b64_tr_b16 a[66:67], v19 offset:29696
    s_waitcnt lgkmcnt(4)
    v_mfma_f32_32x32x16_bf16 v[124:139], a[52:55], v[52:55], v[124:139]
    v_mfma_f32_32x32x16_bf16 v[140:155], a[56:59], v[52:55], v[140:155]
    s_waitcnt lgkmcnt(0)
    v_mfma_f32_32x32x16_bf16 v[156:171], a[60:63], v[52:55], v[156:171]
    v_mfma_f32_32x32x16_bf16 v[172:187], a[64:67], v[52:55], v[172:187]
    s_nop 7
    v_pk_mul_f32 v[124:125], v[124:125], s[60:61]
    v_pk_mul_f32 v[126:127], v[126:127], s[60:61]
    v_pk_mul_f32 v[128:129], v[128:129], s[60:61]
    v_pk_mul_f32 v[130:131], v[130:131], s[60:61]
    v_pk_mul_f32 v[132:133], v[132:133], s[60:61]
    v_pk_mul_f32 v[134:135], v[134:135], s[60:61]
    v_pk_mul_f32 v[136:137], v[136:137], s[60:61]
    v_pk_mul_f32 v[138:139], v[138:139], s[60:61]
    v_cvt_pk_bf16_f32 v108, v124, v125
    v_cvt_pk_bf16_f32 v109, v126, v127
    v_cvt_pk_bf16_f32 v110, v128, v129
    v_cvt_pk_bf16_f32 v111, v130, v131
    v_accvgpr_write_b32 a0, v108
    v_accvgpr_write_b32 a1, v109
    v_accvgpr_write_b32 a2, v110
    v_accvgpr_write_b32 a3, v111
    v_cvt_pk_bf16_f32 v112, v132, v133
    v_cvt_pk_bf16_f32 v113, v134, v135
    v_cvt_pk_bf16_f32 v114, v136, v137
    v_cvt_pk_bf16_f32 v115, v138, v139
    v_accvgpr_write_b32 a4, v112
    v_accvgpr_write_b32 a5, v113
    v_accvgpr_write_b32 a6, v114
    v_accvgpr_write_b32 a7, v115
    s_barrier
    ds_read_b128 a[52:55], v24 offset:0
    ds_read_b128 a[56:59], v24 offset:8192
    ds_read_b128 a[60:63], v25 offset:0
    ds_read_b128 a[64:67], v25 offset:8192
    s_waitcnt lgkmcnt(2)
    v_mfma_f32_32x32x16_bf16 v[76:91], a[52:55], a[0:3], 0
    v_mul_f32 v140, s60, v140
    v_mul_f32 v141, s60, v141
    v_mul_f32 v142, s60, v142
    v_mul_f32 v143, s60, v143
    v_mul_f32 v144, s60, v144
    v_mul_f32 v145, s60, v145
    v_mul_f32 v146, s60, v146
    v_mul_f32 v147, s60, v147
    ds_read_b128 a[52:55], v26 offset:0
    v_mfma_f32_32x32x16_bf16 v[92:107], a[56:59], a[0:3], 0
    v_mul_f32 v148, s60, v148
    v_mul_f32 v149, s60, v149
    v_mul_f32 v150, s60, v150
    v_mul_f32 v151, s60, v151
    v_mul_f32 v152, s60, v152
    v_mul_f32 v153, s60, v153
    v_mul_f32 v154, s60, v154
    v_mul_f32 v155, s60, v155
    ds_read_b128 a[56:59], v26 offset:8192
    s_waitcnt lgkmcnt(2)
    v_mfma_f32_32x32x16_bf16 v[76:91], a[60:63], a[4:7], v[76:91]
    v_cvt_pk_bf16_f32 v116, v140, v141
    v_cvt_pk_bf16_f32 v117, v142, v143
    v_cvt_pk_bf16_f32 v118, v144, v145
    v_cvt_pk_bf16_f32 v119, v146, v147
    v_accvgpr_write_b32 a8, v116
    v_accvgpr_write_b32 a9, v117
    v_accvgpr_write_b32 a10, v118
    v_accvgpr_write_b32 a11, v119
    ds_read_b128 a[60:63], v27 offset:0
    v_mfma_f32_32x32x16_bf16 v[92:107], a[64:67], a[4:7], v[92:107]
    v_cvt_pk_bf16_f32 v120, v148, v149
    v_cvt_pk_bf16_f32 v121, v150, v151
    v_cvt_pk_bf16_f32 v122, v152, v153
    v_cvt_pk_bf16_f32 v123, v154, v155
    v_accvgpr_write_b32 a12, v120
    v_accvgpr_write_b32 a13, v121
    v_accvgpr_write_b32 a14, v122
    v_accvgpr_write_b32 a15, v123
    ds_read_b128 a[64:67], v27 offset:8192
    s_waitcnt lgkmcnt(2)
    v_mfma_f32_32x32x16_bf16 v[76:91], a[52:55], a[8:11], v[76:91]
    v_mul_f32 v156, s60, v156
    v_mul_f32 v157, s60, v157
    v_mul_f32 v158, s60, v158
    v_mul_f32 v159, s60, v159
    v_mul_f32 v160, s60, v160
    v_mul_f32 v161, s60, v161
    v_mul_f32 v162, s60, v162
    v_mul_f32 v163, s60, v163
    ds_read_b128 a[52:55], v28 offset:0
    v_mfma_f32_32x32x16_bf16 v[92:107], a[56:59], a[8:11], v[92:107]
    v_mul_f32 v164, s60, v164
    v_mul_f32 v165, s60, v165
    v_mul_f32 v166, s60, v166
    v_mul_f32 v167, s60, v167
    v_mul_f32 v168, s60, v168
    v_mul_f32 v169, s60, v169
    v_mul_f32 v170, s60, v170
    v_mul_f32 v171, s60, v171
    ds_read_b128 a[56:59], v28 offset:8192
    s_waitcnt lgkmcnt(2)
    v_mfma_f32_32x32x16_bf16 v[76:91], a[60:63], a[12:15], v[76:91]
    v_cvt_pk_bf16_f32 v108, v156, v157
    v_cvt_pk_bf16_f32 v109, v158, v159
    v_cvt_pk_bf16_f32 v110, v160, v161
    v_cvt_pk_bf16_f32 v111, v162, v163
    v_accvgpr_write_b32 a16, v108
    v_accvgpr_write_b32 a17, v109
    v_accvgpr_write_b32 a18, v110
    v_accvgpr_write_b32 a19, v111
    ds_read_b128 a[60:63], v29 offset:0
    v_mfma_f32_32x32x16_bf16 v[92:107], a[64:67], a[12:15], v[92:107]
    v_cvt_pk_bf16_f32 v112, v164, v165
    v_cvt_pk_bf16_f32 v113, v166, v167
    v_cvt_pk_bf16_f32 v114, v168, v169
    v_cvt_pk_bf16_f32 v115, v170, v171
    v_accvgpr_write_b32 a20, v112
    v_accvgpr_write_b32 a21, v113
    v_accvgpr_write_b32 a22, v114
    v_accvgpr_write_b32 a23, v115
    ds_read_b128 a[64:67], v29 offset:8192
    s_waitcnt lgkmcnt(2)
    v_mfma_f32_32x32x16_bf16 v[76:91], a[52:55], a[16:19], v[76:91]
    v_mul_f32 v172, s60, v172
    v_mul_f32 v173, s60, v173
    v_mul_f32 v174, s60, v174
    v_mul_f32 v175, s60, v175
    v_mul_f32 v176, s60, v176
    v_mul_f32 v177, s60, v177
    v_mul_f32 v178, s60, v178
    v_mul_f32 v179, s60, v179
    ds_read_b128 a[52:55], v30 offset:0
    v_mfma_f32_32x32x16_bf16 v[92:107], a[56:59], a[16:19], v[92:107]
    v_mul_f32 v180, s60, v180
    v_mul_f32 v181, s60, v181
    v_mul_f32 v182, s60, v182
    v_mul_f32 v183, s60, v183
    v_mul_f32 v184, s60, v184
    v_mul_f32 v185, s60, v185
    v_mul_f32 v186, s60, v186
    v_mul_f32 v187, s60, v187
    ds_read_b128 a[56:59], v30 offset:8192
    s_waitcnt lgkmcnt(2)
    v_mfma_f32_32x32x16_bf16 v[76:91], a[60:63], a[20:23], v[76:91]
    v_cvt_pk_bf16_f32 v116, v172, v173
    v_cvt_pk_bf16_f32 v117, v174, v175
    v_cvt_pk_bf16_f32 v118, v176, v177
    v_cvt_pk_bf16_f32 v119, v178, v179
    v_accvgpr_write_b32 a24, v116
    v_accvgpr_write_b32 a25, v117
    v_accvgpr_write_b32 a26, v118
    v_accvgpr_write_b32 a27, v119
    ds_read_b128 a[60:63], v31 offset:0
    v_mfma_f32_32x32x16_bf16 v[92:107], a[64:67], a[20:23], v[92:107]
    v_cvt_pk_bf16_f32 v120, v180, v181
    v_cvt_pk_bf16_f32 v121, v182, v183
    v_cvt_pk_bf16_f32 v122, v184, v185
    v_cvt_pk_bf16_f32 v123, v186, v187
    v_accvgpr_write_b32 a28, v120
    v_accvgpr_write_b32 a29, v121
    v_accvgpr_write_b32 a30, v122
    v_accvgpr_write_b32 a31, v123
    ds_read_b128 a[64:67], v31 offset:8192
    s_waitcnt lgkmcnt(2)
    v_mfma_f32_32x32x16_bf16 v[76:91], a[52:55], a[24:27], v[76:91]
    v_mfma_f32_32x32x16_bf16 v[92:107], a[56:59], a[24:27], v[92:107]
    s_waitcnt lgkmcnt(0)
    v_mfma_f32_32x32x16_bf16 v[76:91], a[60:63], a[28:31], v[76:91]
    v_mfma_f32_32x32x16_bf16 v[92:107], a[64:67], a[28:31], v[92:107]
    s_nop 10
    v_max3_f32 v39, v76, v77, v78
    v_max3_f32 v40, v79, v80, v81
    v_max3_f32 v39, v39, v82, v83
    v_max3_f32 v40, v40, v84, v85
    v_max3_f32 v39, v39, v86, v87
    v_max3_f32 v40, v40, v88, v89
    v_max3_f32 v39, v39, v90, v91
    v_max3_f32 v40, v40, v92, v93
    v_max3_f32 v39, v39, v94, v95
    v_max3_f32 v40, v40, v96, v97
    v_max3_f32 v39, v39, v98, v99
    v_max3_f32 v40, v40, v100, v101
    v_max3_f32 v39, v39, v102, v103
    v_max3_f32 v40, v40, v104, v105
    v_max3_f32 v39, v39, v106, v107
    v_max_f32 v39, v39, v40
    v_mov_b32 v40, v39
    s_nop 1
    v_permlane32_swap_b32 v39, v40
    v_max_f32 v36, v39, v40
    v_sub_f32 v8, 0, v36
    v_mov_b32 v9, v8
    v_mov_b32 v10, v8
    v_mov_b32 v11, v8
    v_mov_b32 v12, v8
    v_mov_b32 v13, v8
    v_mov_b32 v14, v8
    v_mov_b32 v15, v8
    v_mov_b32 v16, v8
    v_mov_b32 v17, v8
    v_mov_b32 v18, v8
    v_mov_b32 v19, v8
    v_mov_b32 v20, v8
    v_mov_b32 v21, v8
    v_mov_b32 v22, v8
    v_mov_b32 v23, v8
    v_mov_b32 v37, v36
    v_mov_b32 v38, 0x41000000
    v_pk_add_f32 v[76:77], v[76:77], v[8:9]
    v_pk_add_f32 v[78:79], v[78:79], v[8:9]
    v_pk_add_f32 v[80:81], v[80:81], v[8:9]
    v_pk_add_f32 v[82:83], v[82:83], v[8:9]
    v_pk_add_f32 v[84:85], v[84:85], v[8:9]
    v_pk_add_f32 v[86:87], v[86:87], v[8:9]
    v_pk_add_f32 v[88:89], v[88:89], v[8:9]
    v_pk_add_f32 v[90:91], v[90:91], v[8:9]
    v_pk_add_f32 v[92:93], v[92:93], v[8:9]
    v_pk_add_f32 v[94:95], v[94:95], v[8:9]
    v_pk_add_f32 v[96:97], v[96:97], v[8:9]
    v_pk_add_f32 v[98:99], v[98:99], v[8:9]
    v_pk_add_f32 v[100:101], v[100:101], v[8:9]
    v_pk_add_f32 v[102:103], v[102:103], v[8:9]
    v_pk_add_f32 v[104:105], v[104:105], v[8:9]
    v_pk_add_f32 v[106:107], v[106:107], v[8:9]
    s_barrier
    v_add_u32 v24, 16384, v24
    v_add_u32 v25, 16384, v25
    v_add_u32 v26, 16384, v26
    v_add_u32 v27, 16384, v27
    v_add_u32 v28, 16384, v28
    v_add_u32 v29, 16384, v29
    v_add_u32 v30, 16384, v30
    v_add_u32 v31, 16384, v31
    ds_read_b128 a[52:55], v24 offset:0
    ds_read_b128 a[56:59], v24 offset:8192
    ds_read_b128 a[60:63], v25 offset:0
    ds_read_b128 a[64:67], v25 offset:8192
    s_waitcnt lgkmcnt(2)
    v_mfma_f32_32x32x16_bf16 v[44:59], a[52:55], a[0:3], v[8:23]
    v_exp_f32 v76, v76
    ds_read_b128 a[52:55], v26 offset:0
    v_mfma_f32_32x32x16_bf16 v[60:75], a[56:59], a[0:3], v[8:23]
    v_exp_f32 v77, v77
    v_exp_f32 v78, v78
    ds_read_b128 a[56:59], v26 offset:8192
    s_waitcnt lgkmcnt(2)
    v_mfma_f32_32x32x16_bf16 v[44:59], a[60:63], a[4:7], v[44:59]
    v_exp_f32 v79, v79
    ds_read_b128 a[60:63], v27 offset:0
    v_mfma_f32_32x32x16_bf16 v[60:75], a[64:67], a[4:7], v[60:75]
    v_exp_f32 v80, v80
    ds_read_b128 a[64:67], v27 offset:8192
    s_waitcnt lgkmcnt(2)
    v_mfma_f32_32x32x16_bf16 v[44:59], a[52:55], a[8:11], v[44:59]
    v_exp_f32 v81, v81
    ds_read_b128 a[52:55], v28 offset:0
    v_mfma_f32_32x32x16_bf16 v[60:75], a[56:59], a[8:11], v[60:75]
    v_exp_f32 v82, v82
    v_exp_f32 v83, v83
    ds_read_b128 a[56:59], v28 offset:8192
    s_waitcnt lgkmcnt(2)
    v_mfma_f32_32x32x16_bf16 v[44:59], a[60:63], a[12:15], v[44:59]
    v_cvt_pk_bf16_f32 v108, v76, v77
    v_cvt_pk_bf16_f32 v109, v78, v79
    ds_read_b128 a[60:63], v29 offset:0
    v_mfma_f32_32x32x16_bf16 v[60:75], a[64:67], a[12:15], v[60:75]
    v_cvt_pk_bf16_f32 v110, v80, v81
    v_cvt_pk_bf16_f32 v111, v82, v83
    ds_read_b128 a[64:67], v29 offset:8192
    s_waitcnt lgkmcnt(2)
    v_mfma_f32_32x32x16_bf16 v[44:59], a[52:55], a[16:19], v[44:59]
    v_exp_f32 v84, v84
    ds_read_b128 a[52:55], v30 offset:0
    v_mfma_f32_32x32x16_bf16 v[60:75], a[56:59], a[16:19], v[60:75]
    v_exp_f32 v85, v85
    v_exp_f32 v86, v86
    ds_read_b128 a[56:59], v30 offset:8192
    s_waitcnt lgkmcnt(2)
    v_mfma_f32_32x32x16_bf16 v[44:59], a[60:63], a[20:23], v[44:59]
    v_exp_f32 v87, v87
    ds_read_b128 a[60:63], v31 offset:0
    v_mfma_f32_32x32x16_bf16 v[60:75], a[64:67], a[20:23], v[60:75]
    v_exp_f32 v88, v88
    ds_read_b128 a[64:67], v31 offset:8192
    s_waitcnt lgkmcnt(2)
    v_mfma_f32_32x32x16_bf16 v[44:59], a[52:55], a[24:27], v[44:59]
    v_exp_f32 v89, v89
    ds_read_b64_tr_b16 a[52:53], v32 offset:0
    ds_read_b64_tr_b16 a[54:55], v32 offset:2048
    v_mfma_f32_32x32x16_bf16 v[60:75], a[56:59], a[24:27], v[60:75]
    v_exp_f32 v90, v90
    ds_read_b64_tr_b16 a[56:57], v33 offset:0
    ds_read_b64_tr_b16 a[58:59], v33 offset:2048
    s_waitcnt lgkmcnt(4)
    v_mfma_f32_32x32x16_bf16 v[44:59], a[60:63], a[28:31], v[44:59]
    v_exp_f32 v91, v91
    ds_read_b64_tr_b16 a[60:61], v34 offset:0
    ds_read_b64_tr_b16 a[62:63], v34 offset:2048
    v_mfma_f32_32x32x16_bf16 v[60:75], a[64:67], a[28:31], v[60:75]
    v_cvt_pk_bf16_f32 v112, v84, v85
    ds_read_b64_tr_b16 a[64:65], v35 offset:0
    ds_read_b64_tr_b16 a[66:67], v35 offset:2048
    s_waitcnt lgkmcnt(4)
    v_mfma_f32_32x32x16_bf16 v[124:139], a[52:55], v[108:111], 0
    v_cvt_pk_bf16_f32 v113, v86, v87
    ds_read_b64_tr_b16 a[52:53], v32 offset:4096
    ds_read_b64_tr_b16 a[54:55], v32 offset:6144
    v_mfma_f32_32x32x16_bf16 v[140:155], a[56:59], v[108:111], 0
    v_cvt_pk_bf16_f32 v114, v88, v89
    v_cvt_pk_bf16_f32 v115, v90, v91
    ds_read_b64_tr_b16 a[56:57], v33 offset:4096
    ds_read_b64_tr_b16 a[58:59], v33 offset:6144
    s_waitcnt lgkmcnt(4)
    v_mfma_f32_32x32x16_bf16 v[156:171], a[60:63], v[108:111], 0
    v_exp_f32 v92, v92
    ds_read_b64_tr_b16 a[60:61], v34 offset:4096
    ds_read_b64_tr_b16 a[62:63], v34 offset:6144
    v_mfma_f32_32x32x16_bf16 v[172:187], a[64:67], v[108:111], 0
    v_mfma_f32_32x32x16_bf16 a[36:51], a[32:35], v[108:111], 0
    v_exp_f32 v93, v93
    v_exp_f32 v94, v94
    v_exp_f32 v95, v95
    ds_read_b64_tr_b16 a[64:65], v35 offset:4096
    ds_read_b64_tr_b16 a[66:67], v35 offset:6144
    s_waitcnt lgkmcnt(4)
    v_mfma_f32_32x32x16_bf16 v[124:139], a[52:55], v[112:115], v[124:139]
    v_exp_f32 v96, v96
    ds_read_b64_tr_b16 a[52:53], v32 offset:8192
    ds_read_b64_tr_b16 a[54:55], v32 offset:10240
    v_mfma_f32_32x32x16_bf16 v[140:155], a[56:59], v[112:115], v[140:155]
    v_exp_f32 v97, v97
    v_exp_f32 v98, v98
    ds_read_b64_tr_b16 a[56:57], v33 offset:8192
    ds_read_b64_tr_b16 a[58:59], v33 offset:10240
    s_waitcnt lgkmcnt(4)
    v_mfma_f32_32x32x16_bf16 v[156:171], a[60:63], v[112:115], v[156:171]
    v_exp_f32 v99, v99
    ds_read_b64_tr_b16 a[60:61], v34 offset:8192
    ds_read_b64_tr_b16 a[62:63], v34 offset:10240
    v_mfma_f32_32x32x16_bf16 v[172:187], a[64:67], v[112:115], v[172:187]
    v_mfma_f32_32x32x16_bf16 a[36:51], a[32:35], v[112:115], a[36:51]
    v_cvt_pk_bf16_f32 v116, v92, v93
    v_cvt_pk_bf16_f32 v117, v94, v95
    v_cvt_pk_bf16_f32 v118, v96, v97
    v_cvt_pk_bf16_f32 v119, v98, v99
    v_exp_f32 v100, v100
    v_exp_f32 v101, v101
    v_exp_f32 v102, v102
    v_exp_f32 v103, v103
    v_exp_f32 v104, v104
    ds_read_b64_tr_b16 a[64:65], v35 offset:8192
    ds_read_b64_tr_b16 a[66:67], v35 offset:10240
    s_waitcnt lgkmcnt(4)
    v_mfma_f32_32x32x16_bf16 v[124:139], a[52:55], v[116:119], v[124:139]
    v_exp_f32 v105, v105
    ds_read_b64_tr_b16 a[52:53], v32 offset:12288
    ds_read_b64_tr_b16 a[54:55], v32 offset:14336
    v_mfma_f32_32x32x16_bf16 v[140:155], a[56:59], v[116:119], v[140:155]
    ds_read_b64_tr_b16 a[56:57], v33 offset:12288
    ds_read_b64_tr_b16 a[58:59], v33 offset:14336
    s_waitcnt lgkmcnt(4)
    v_mfma_f32_32x32x16_bf16 v[156:171], a[60:63], v[116:119], v[156:171]
    v_exp_f32 v106, v106
    ds_read_b64_tr_b16 a[60:61], v34 offset:12288
    ds_read_b64_tr_b16 a[62:63], v34 offset:14336
    v_mfma_f32_32x32x16_bf16 v[172:187], a[64:67], v[116:119], v[172:187]
    v_mfma_f32_32x32x16_bf16 a[36:51], a[32:35], v[116:119], a[36:51]
    v_exp_f32 v107, v107
    v_cvt_pk_bf16_f32 v120, v100, v101
    v_cvt_pk_bf16_f32 v121, v102, v103
    v_cvt_pk_bf16_f32 v122, v104, v105
    v_cvt_pk_bf16_f32 v123, v106, v107
    v_max3_f32 v39, v44, v45, v46
    v_max3_f32 v40, v47, v48, v49
    ds_read_b64_tr_b16 a[64:65], v35 offset:12288
    ds_read_b64_tr_b16 a[66:67], v35 offset:14336
    s_waitcnt lgkmcnt(4)
    v_mfma_f32_32x32x16_bf16 v[124:139], a[52:55], v[120:123], v[124:139]
    v_max3_f32 v39, v39, v50, v51
    s_barrier
    v_add_u32 v24, 32768, v24
    v_add_u32 v25, 32768, v25
    v_add_u32 v26, 32768, v26
    v_add_u32 v27, 32768, v27
    v_add_u32 v28, 32768, v28
    v_add_u32 v29, 32768, v29
    v_add_u32 v30, 32768, v30
    v_add_u32 v31, 32768, v31
    ds_read_b128 a[52:55], v24 offset:0
    v_mfma_f32_32x32x16_bf16 v[140:155], a[56:59], v[120:123], v[140:155]
    v_max3_f32 v40, v40, v52, v53
    v_max3_f32 v39, v39, v54, v55
    v_max3_f32 v40, v40, v56, v57
    ds_read_b128 a[56:59], v24 offset:8192
    s_waitcnt lgkmcnt(2)
    v_mfma_f32_32x32x16_bf16 v[156:171], a[60:63], v[120:123], v[156:171]
    v_max3_f32 v39, v39, v58, v59
    v_max3_f32 v40, v40, v60, v61
    ds_read_b128 a[60:63], v25 offset:0
    v_mfma_f32_32x32x16_bf16 v[172:187], a[64:67], v[120:123], v[172:187]
    v_mfma_f32_32x32x16_bf16 a[36:51], a[32:35], v[120:123], a[36:51]
    v_max3_f32 v39, v39, v62, v63
    v_max3_f32 v40, v40, v64, v65
    v_max3_f32 v39, v39, v66, v67
    v_max3_f32 v40, v40, v68, v69
    v_max3_f32 v39, v39, v70, v71
    v_max3_f32 v40, v40, v72, v73
    v_max3_f32 v39, v39, v74, v75
    v_max_f32 v39, v39, v40
    v_cmp_gt_f32 vcc, v39, v38
    ds_read_b128 a[64:67], v25 offset:8192
    s_waitcnt lgkmcnt(2)
    v_mfma_f32_32x32x16_bf16 v[76:91], a[52:55], a[0:3], v[8:23]
    ds_read_b128 a[52:55], v26 offset:0
    v_mfma_f32_32x32x16_bf16 v[92:107], a[56:59], a[0:3], v[8:23]
    s_cbranch_vccnz L_resc_1
L_resc_1_back:
    ds_read_b128 a[56:59], v26 offset:8192
    s_waitcnt lgkmcnt(2)
    v_mfma_f32_32x32x16_bf16 v[76:91], a[60:63], a[4:7], v[76:91]
    v_exp_f32 v44, v44
    ds_read_b128 a[60:63], v27 offset:0
    v_mfma_f32_32x32x16_bf16 v[92:107], a[64:67], a[4:7], v[92:107]
    v_exp_f32 v45, v45
    v_exp_f32 v46, v46
    ds_read_b128 a[64:67], v27 offset:8192
    s_waitcnt lgkmcnt(2)
    v_mfma_f32_32x32x16_bf16 v[76:91], a[52:55], a[8:11], v[76:91]
    v_exp_f32 v47, v47
    ds_read_b128 a[52:55], v28 offset:0
    v_mfma_f32_32x32x16_bf16 v[92:107], a[56:59], a[8:11], v[92:107]
    v_exp_f32 v48, v48
    v_exp_f32 v49, v49
    ds_read_b128 a[56:59], v28 offset:8192
    s_waitcnt lgkmcnt(2)
    v_mfma_f32_32x32x16_bf16 v[76:91], a[60:63], a[12:15], v[76:91]
    v_exp_f32 v50, v50
    ds_read_b128 a[60:63], v29 offset:0
    v_mfma_f32_32x32x16_bf16 v[92:107], a[64:67], a[12:15], v[92:107]
    v_exp_f32 v51, v51
    v_cvt_pk_bf16_f32 v108, v44, v45
    ds_read_b128 a[64:67], v29 offset:8192
    s_waitcnt lgkmcnt(2)
    v_mfma_f32_32x32x16_bf16 v[76:91], a[52:55], a[16:19], v[76:91]
    v_cvt_pk_bf16_f32 v109, v46, v47
    v_cvt_pk_bf16_f32 v110, v48, v49
    v_cvt_pk_bf16_f32 v111, v50, v51
    ds_read_b128 a[52:55], v30 offset:0
    v_mfma_f32_32x32x16_bf16 v[92:107], a[56:59], a[16:19], v[92:107]
    v_exp_f32 v52, v52
    v_exp_f32 v53, v53
    ds_read_b128 a[56:59], v30 offset:8192
    s_waitcnt lgkmcnt(2)
    v_mfma_f32_32x32x16_bf16 v[76:91], a[60:63], a[20:23], v[76:91]
    v_exp_f32 v54, v54
    ds_read_b128 a[60:63], v31 offset:0
    v_mfma_f32_32x32x16_bf16 v[92:107], a[64:67], a[20:23], v[92:107]
    v_exp_f32 v55, v55
    ds_read_b128 a[64:67], v31 offset:8192
    s_waitcnt lgkmcnt(2)
    v_mfma_f32_32x32x16_bf16 v[76:91], a[52:55], a[24:27], v[76:91]
    v_exp_f32 v56, v56
    v_exp_f32 v57, v57
    v_subrev_u32 v32, 98304, v32
    v_subrev_u32 v33, 98304, v33
    v_subrev_u32 v34, 98304, v34
    v_subrev_u32 v35, 98304, v35
    ds_read_b64_tr_b16 a[52:53], v32 offset:0
    ds_read_b64_tr_b16 a[54:55], v32 offset:2048
    v_mfma_f32_32x32x16_bf16 v[92:107], a[56:59], a[24:27], v[92:107]
    v_exp_f32 v58, v58
    ds_read_b64_tr_b16 a[56:57], v33 offset:0
    ds_read_b64_tr_b16 a[58:59], v33 offset:2048
    s_waitcnt lgkmcnt(4)
    v_mfma_f32_32x32x16_bf16 v[76:91], a[60:63], a[28:31], v[76:91]
    v_exp_f32 v59, v59
    ds_read_b64_tr_b16 a[60:61], v34 offset:0
    ds_read_b64_tr_b16 a[62:63], v34 offset:2048
    v_mfma_f32_32x32x16_bf16 v[92:107], a[64:67], a[28:31], v[92:107]
    v_cvt_pk_bf16_f32 v112, v52, v53
    ds_read_b64_tr_b16 a[64:65], v35 offset:0
    ds_read_b64_tr_b16 a[66:67], v35 offset:2048
    s_waitcnt lgkmcnt(4)
    v_mfma_f32_32x32x16_bf16 v[124:139], a[52:55], v[108:111], v[124:139]
    v_cvt_pk_bf16_f32 v113, v54, v55
    ds_read_b64_tr_b16 a[52:53], v32 offset:4096
    ds_read_b64_tr_b16 a[54:55], v32 offset:6144
    v_mfma_f32_32x32x16_bf16 v[140:155], a[56:59], v[108:111], v[140:155]
    v_cvt_pk_bf16_f32 v114, v56, v57
    v_cvt_pk_bf16_f32 v115, v58, v59
    ds_read_b64_tr_b16 a[56:57], v33 offset:4096
    ds_read_b64_tr_b16 a[58:59], v33 offset:6144
    s_waitcnt lgkmcnt(4)
    v_mfma_f32_32x32x16_bf16 v[156:171], a[60:63], v[108:111], v[156:171]
    v_exp_f32 v60, v60
    ds_read_b64_tr_b16 a[60:61], v34 offset:4096
    ds_read_b64_tr_b16 a[62:63], v34 offset:6144
    v_mfma_f32_32x32x16_bf16 v[172:187], a[64:67], v[108:111], v[172:187]
    v_mfma_f32_32x32x16_bf16 a[36:51], a[32:35], v[108:111], a[36:51]
    v_exp_f32 v61, v61
    v_exp_f32 v62, v62
    v_exp_f32 v63, v63
    ds_read_b64_tr_b16 a[64:65], v35 offset:4096
    ds_read_b64_tr_b16 a[66:67], v35 offset:6144
    s_waitcnt lgkmcnt(4)
    v_mfma_f32_32x32x16_bf16 v[124:139], a[52:55], v[112:115], v[124:139]
    v_exp_f32 v64, v64
    ds_read_b64_tr_b16 a[52:53], v32 offset:8192
    ds_read_b64_tr_b16 a[54:55], v32 offset:10240
    v_mfma_f32_32x32x16_bf16 v[140:155], a[56:59], v[112:115], v[140:155]
    v_exp_f32 v65, v65
    v_exp_f32 v66, v66
    ds_read_b64_tr_b16 a[56:57], v33 offset:8192
    ds_read_b64_tr_b16 a[58:59], v33 offset:10240
    s_waitcnt lgkmcnt(4)
    v_mfma_f32_32x32x16_bf16 v[156:171], a[60:63], v[112:115], v[156:171]
    v_exp_f32 v67, v67
    ds_read_b64_tr_b16 a[60:61], v34 offset:8192
    ds_read_b64_tr_b16 a[62:63], v34 offset:10240
    v_mfma_f32_32x32x16_bf16 v[172:187], a[64:67], v[112:115], v[172:187]
    v_mfma_f32_32x32x16_bf16 a[36:51], a[32:35], v[112:115], a[36:51]
    v_cvt_pk_bf16_f32 v116, v60, v61
    v_cvt_pk_bf16_f32 v117, v62, v63
    v_cvt_pk_bf16_f32 v118, v64, v65
    v_cvt_pk_bf16_f32 v119, v66, v67
    v_exp_f32 v68, v68
    v_exp_f32 v69, v69
    v_exp_f32 v70, v70
    v_exp_f32 v71, v71
    v_exp_f32 v72, v72
    ds_read_b64_tr_b16 a[64:65], v35 offset:8192
    ds_read_b64_tr_b16 a[66:67], v35 offset:10240
    s_waitcnt lgkmcnt(4)
    v_mfma_f32_32x32x16_bf16 v[124:139], a[52:55], v[116:119], v[124:139]
    v_exp_f32 v73, v73
    ds_read_b64_tr_b16 a[52:53], v32 offset:12288
    ds_read_b64_tr_b16 a[54:55], v32 offset:14336
    v_mfma_f32_32x32x16_bf16 v[140:155], a[56:59], v[116:119], v[140:155]
    ds_read_b64_tr_b16 a[56:57], v33 offset:12288
    ds_read_b64_tr_b16 a[58:59], v33 offset:14336
    s_waitcnt lgkmcnt(4)
    v_mfma_f32_32x32x16_bf16 v[156:171], a[60:63], v[116:119], v[156:171]
    v_exp_f32 v74, v74
    ds_read_b64_tr_b16 a[60:61], v34 offset:12288
    ds_read_b64_tr_b16 a[62:63], v34 offset:14336
    v_mfma_f32_32x32x16_bf16 v[172:187], a[64:67], v[116:119], v[172:187]
    v_mfma_f32_32x32x16_bf16 a[36:51], a[32:35], v[116:119], a[36:51]
    v_exp_f32 v75, v75
    v_cvt_pk_bf16_f32 v120, v68, v69
    v_cvt_pk_bf16_f32 v121, v70, v71
    v_cvt_pk_bf16_f32 v122, v72, v73
    v_cvt_pk_bf16_f32 v123, v74, v75
    v_max3_f32 v39, v76, v77, v78
    v_max3_f32 v40, v79, v80, v81
    ds_read_b64_tr_b16 a[64:65], v35 offset:12288
    ds_read_b64_tr_b16 a[66:67], v35 offset:14336
    s_waitcnt lgkmcnt(4)
    v_mfma_f32_32x32x16_bf16 v[124:139], a[52:55], v[120:123], v[124:139]
    v_max3_f32 v39, v39, v82, v83
    s_barrier
    v_subrev_u32 v24, 98304, v24
    v_subrev_u32 v25, 98304, v25
    v_subrev_u32 v26, 98304, v26
    v_subrev_u32 v27, 98304, v27
    v_subrev_u32 v28, 98304, v28
    v_subrev_u32 v29, 98304, v29
    v_subrev_u32 v30, 98304, v30
    v_subrev_u32 v31, 98304, v31
    ds_read_b128 a[52:55], v24 offset:0
    v_mfma_f32_32x32x16_bf16 v[140:155], a[56:59], v[120:123], v[140:155]
    v_max3_f32 v40, v40, v84, v85
    v_max3_f32 v39, v39, v86, v87
    v_max3_f32 v40, v40, v88, v89
    ds_read_b128 a[56:59], v24 offset:8192
    s_waitcnt lgkmcnt(2)
    v_mfma_f32_32x32x16_bf16 v[156:171], a[60:63], v[120:123], v[156:171]
    v_max3_f32 v39, v39, v90, v91
    v_max3_f32 v40, v40, v92, v93
    ds_read_b128 a[60:63], v25 offset:0
    v_mfma_f32_32x32x16_bf16 v[172:187], a[64:67], v[120:123], v[172:187]
    v_mfma_f32_32x32x16_bf16 a[36:51], a[32:35], v[120:123], a[36:51]
    v_max3_f32 v39, v39, v94, v95
    v_max3_f32 v40, v40, v96, v97
    v_max3_f32 v39, v39, v98, v99
    v_max3_f32 v40, v40, v100, v101
    v_max3_f32 v39, v39, v102, v103
    v_max3_f32 v40, v40, v104, v105
    v_max3_f32 v39, v39, v106, v107
    v_max_f32 v39, v39, v40
    v_cmp_gt_f32 vcc, v39, v38
    ds_read_b128 a[64:67], v25 offset:8192
    s_waitcnt lgkmcnt(2)
    v_mfma_f32_32x32x16_bf16 v[44:59], a[52:55], a[0:3], v[8:23]
    ds_read_b128 a[52:55], v26 offset:0
    v_mfma_f32_32x32x16_bf16 v[60:75], a[56:59], a[0:3], v[8:23]
    s_cbranch_vccnz L_resc_2
L_resc_2_back:
    ds_read_b128 a[56:59], v26 offset:8192
    s_waitcnt lgkmcnt(2)
    v_mfma_f32_32x32x16_bf16 v[44:59], a[60:63], a[4:7], v[44:59]
    v_exp_f32 v76, v76
    ds_read_b128 a[60:63], v27 offset:0
    v_mfma_f32_32x32x16_bf16 v[60:75], a[64:67], a[4:7], v[60:75]
    v_exp_f32 v77, v77
    v_exp_f32 v78, v78
    ds_read_b128 a[64:67], v27 offset:8192
    s_waitcnt lgkmcnt(2)
    v_mfma_f32_32x32x16_bf16 v[44:59], a[52:55], a[8:11], v[44:59]
    v_exp_f32 v79, v79
    ds_read_b128 a[52:55], v28 offset:0
    v_mfma_f32_32x32x16_bf16 v[60:75], a[56:59], a[8:11], v[60:75]
    v_exp_f32 v80, v80
    v_exp_f32 v81, v81
    ds_read_b128 a[56:59], v28 offset:8192
    s_waitcnt lgkmcnt(2)
    v_mfma_f32_32x32x16_bf16 v[44:59], a[60:63], a[12:15], v[44:59]
    v_exp_f32 v82, v82
    ds_read_b128 a[60:63], v29 offset:0
    v_mfma_f32_32x32x16_bf16 v[60:75], a[64:67], a[12:15], v[60:75]
    v_exp_f32 v83, v83
    v_cvt_pk_bf16_f32 v108, v76, v77
    ds_read_b128 a[64:67], v29 offset:8192
    s_waitcnt lgkmcnt(2)
    v_mfma_f32_32x32x16_bf16 v[44:59], a[52:55], a[16:19], v[44:59]
    v_cvt_pk_bf16_f32 v109, v78, v79
    v_cvt_pk_bf16_f32 v110, v80, v81
    v_cvt_pk_bf16_f32 v111, v82, v83
    ds_read_b128 a[52:55], v30 offset:0
    v_mfma_f32_32x32x16_bf16 v[60:75], a[56:59], a[16:19], v[60:75]
    v_exp_f32 v84, v84
    v_exp_f32 v85, v85
    ds_read_b128 a[56:59], v30 offset:8192
    s_waitcnt lgkmcnt(2)
    v_mfma_f32_32x32x16_bf16 v[44:59], a[60:63], a[20:23], v[44:59]
    v_exp_f32 v86, v86
    ds_read_b128 a[60:63], v31 offset:0
    v_mfma_f32_32x32x16_bf16 v[60:75], a[64:67], a[20:23], v[60:75]
    v_exp_f32 v87, v87
    ds_read_b128 a[64:67], v31 offset:8192
    s_waitcnt lgkmcnt(2)
    v_mfma_f32_32x32x16_bf16 v[44:59], a[52:55], a[24:27], v[44:59]
    v_exp_f32 v88, v88
    v_exp_f32 v89, v89
    v_add_u32 v32, 32768, v32
    v_add_u32 v33, 32768, v33
    v_add_u32 v34, 32768, v34
    v_add_u32 v35, 32768, v35
    ds_read_b64_tr_b16 a[52:53], v32 offset:0
    ds_read_b64_tr_b16 a[54:55], v32 offset:2048
    v_mfma_f32_32x32x16_bf16 v[60:75], a[56:59], a[24:27], v[60:75]
    v_exp_f32 v90, v90
    ds_read_b64_tr_b16 a[56:57], v33 offset:0
    ds_read_b64_tr_b16 a[58:59], v33 offset:2048
    s_waitcnt lgkmcnt(4)
    v_mfma_f32_32x32x16_bf16 v[44:59], a[60:63], a[28:31], v[44:59]
    v_exp_f32 v91, v91
    ds_read_b64_tr_b16 a[60:61], v34 offset:0
    ds_read_b64_tr_b16 a[62:63], v34 offset:2048
    v_mfma_f32_32x32x16_bf16 v[60:75], a[64:67], a[28:31], v[60:75]
    v_cvt_pk_bf16_f32 v112, v84, v85
    ds_read_b64_tr_b16 a[64:65], v35 offset:0
    ds_read_b64_tr_b16 a[66:67], v35 offset:2048
    s_waitcnt lgkmcnt(4)
    v_mfma_f32_32x32x16_bf16 v[124:139], a[52:55], v[108:111], v[124:139]
    v_cvt_pk_bf16_f32 v113, v86, v87
    ds_read_b64_tr_b16 a[52:53], v32 offset:4096
    ds_read_b64_tr_b16 a[54:55], v32 offset:6144
    v_mfma_f32_32x32x16_bf16 v[140:155], a[56:59], v[108:111], v[140:155]
    v_cvt_pk_bf16_f32 v114, v88, v89
    v_cvt_pk_bf16_f32 v115, v90, v91
    ds_read_b64_tr_b16 a[56:57], v33 offset:4096
    ds_read_b64_tr_b16 a[58:59], v33 offset:6144
    s_waitcnt lgkmcnt(4)
    v_mfma_f32_32x32x16_bf16 v[156:171], a[60:63], v[108:111], v[156:171]
    v_exp_f32 v92, v92
    ds_read_b64_tr_b16 a[60:61], v34 offset:4096
    ds_read_b64_tr_b16 a[62:63], v34 offset:6144
    v_mfma_f32_32x32x16_bf16 v[172:187], a[64:67], v[108:111], v[172:187]
    v_mfma_f32_32x32x16_bf16 a[36:51], a[32:35], v[108:111], a[36:51]
    v_exp_f32 v93, v93
    v_exp_f32 v94, v94
    v_exp_f32 v95, v95
    ds_read_b64_tr_b16 a[64:65], v35 offset:4096
    ds_read_b64_tr_b16 a[66:67], v35 offset:6144
    s_waitcnt lgkmcnt(4)
    v_mfma_f32_32x32x16_bf16 v[124:139], a[52:55], v[112:115], v[124:139]
    v_exp_f32 v96, v96
    ds_read_b64_tr_b16 a[52:53], v32 offset:8192
    ds_read_b64_tr_b16 a[54:55], v32 offset:10240
    v_mfma_f32_32x32x16_bf16 v[140:155], a[56:59], v[112:115], v[140:155]
    v_exp_f32 v97, v97
    v_exp_f32 v98, v98
    ds_read_b64_tr_b16 a[56:57], v33 offset:8192
    ds_read_b64_tr_b16 a[58:59], v33 offset:10240
    s_waitcnt lgkmcnt(4)
    v_mfma_f32_32x32x16_bf16 v[156:171], a[60:63], v[112:115], v[156:171]
    v_exp_f32 v99, v99
    ds_read_b64_tr_b16 a[60:61], v34 offset:8192
    ds_read_b64_tr_b16 a[62:63], v34 offset:10240
    v_mfma_f32_32x32x16_bf16 v[172:187], a[64:67], v[112:115], v[172:187]
    v_mfma_f32_32x32x16_bf16 a[36:51], a[32:35], v[112:115], a[36:51]
    v_cvt_pk_bf16_f32 v116, v92, v93
    v_cvt_pk_bf16_f32 v117, v94, v95
    v_cvt_pk_bf16_f32 v118, v96, v97
    v_cvt_pk_bf16_f32 v119, v98, v99
    v_exp_f32 v100, v100
    v_exp_f32 v101, v101
    v_exp_f32 v102, v102
    v_exp_f32 v103, v103
    v_exp_f32 v104, v104
    ds_read_b64_tr_b16 a[64:65], v35 offset:8192
    ds_read_b64_tr_b16 a[66:67], v35 offset:10240
    s_waitcnt lgkmcnt(4)
    v_mfma_f32_32x32x16_bf16 v[124:139], a[52:55], v[116:119], v[124:139]
    v_exp_f32 v105, v105
    ds_read_b64_tr_b16 a[52:53], v32 offset:12288
    ds_read_b64_tr_b16 a[54:55], v32 offset:14336
    v_mfma_f32_32x32x16_bf16 v[140:155], a[56:59], v[116:119], v[140:155]
    ds_read_b64_tr_b16 a[56:57], v33 offset:12288
    ds_read_b64_tr_b16 a[58:59], v33 offset:14336
    s_waitcnt lgkmcnt(4)
    v_mfma_f32_32x32x16_bf16 v[156:171], a[60:63], v[116:119], v[156:171]
    v_exp_f32 v106, v106
    ds_read_b64_tr_b16 a[60:61], v34 offset:12288
    ds_read_b64_tr_b16 a[62:63], v34 offset:14336
    v_mfma_f32_32x32x16_bf16 v[172:187], a[64:67], v[116:119], v[172:187]
    v_mfma_f32_32x32x16_bf16 a[36:51], a[32:35], v[116:119], a[36:51]
    v_exp_f32 v107, v107
    v_cvt_pk_bf16_f32 v120, v100, v101
    v_cvt_pk_bf16_f32 v121, v102, v103
    v_cvt_pk_bf16_f32 v122, v104, v105
    v_cvt_pk_bf16_f32 v123, v106, v107
    v_max3_f32 v39, v44, v45, v46
    v_max3_f32 v40, v47, v48, v49
    ds_read_b64_tr_b16 a[64:65], v35 offset:12288
    ds_read_b64_tr_b16 a[66:67], v35 offset:14336
    s_waitcnt lgkmcnt(4)
    v_mfma_f32_32x32x16_bf16 v[124:139], a[52:55], v[120:123], v[124:139]
    v_max3_f32 v39, v39, v50, v51
    s_barrier
    v_add_u32 v24, 32768, v24
    v_add_u32 v25, 32768, v25
    v_add_u32 v26, 32768, v26
    v_add_u32 v27, 32768, v27
    v_add_u32 v28, 32768, v28
    v_add_u32 v29, 32768, v29
    v_add_u32 v30, 32768, v30
    v_add_u32 v31, 32768, v31
    ds_read_b128 a[52:55], v24 offset:0
    v_mfma_f32_32x32x16_bf16 v[140:155], a[56:59], v[120:123], v[140:155]
    v_max3_f32 v40, v40, v52, v53
    v_max3_f32 v39, v39, v54, v55
    v_max3_f32 v40, v40, v56, v57
    ds_read_b128 a[56:59], v24 offset:8192
    s_waitcnt lgkmcnt(2)
    v_mfma_f32_32x32x16_bf16 v[156:171], a[60:63], v[120:123], v[156:171]
    v_max3_f32 v39, v39, v58, v59
    v_max3_f32 v40, v40, v60, v61
    ds_read_b128 a[60:63], v25 offset:0
    v_mfma_f32_32x32x16_bf16 v[172:187], a[64:67], v[120:123], v[172:187]
    v_mfma_f32_32x32x16_bf16 a[36:51], a[32:35], v[120:123], a[36:51]
    v_max3_f32 v39, v39, v62, v63
    v_max3_f32 v40, v40, v64, v65
    v_max3_f32 v39, v39, v66, v67
    v_max3_f32 v40, v40, v68, v69
    v_max3_f32 v39, v39, v70, v71
    v_max3_f32 v40, v40, v72, v73
    v_max3_f32 v39, v39, v74, v75
    v_max_f32 v39, v39, v40
    v_cmp_gt_f32 vcc, v39, v38
    ds_read_b128 a[64:67], v25 offset:8192
    s_waitcnt lgkmcnt(2)
    v_mfma_f32_32x32x16_bf16 v[76:91], a[52:55], a[0:3], v[8:23]
    ds_read_b128 a[52:55], v26 offset:0
    v_mfma_f32_32x32x16_bf16 v[92:107], a[56:59], a[0:3], v[8:23]
    s_cbranch_vccnz L_resc_3
L_resc_3_back:
    ds_read_b128 a[56:59], v26 offset:8192
    s_waitcnt lgkmcnt(2)
    v_mfma_f32_32x32x16_bf16 v[76:91], a[60:63], a[4:7], v[76:91]
    v_exp_f32 v44, v44
    ds_read_b128 a[60:63], v27 offset:0
    v_mfma_f32_32x32x16_bf16 v[92:107], a[64:67], a[4:7], v[92:107]
    v_exp_f32 v45, v45
    v_exp_f32 v46, v46
    ds_read_b128 a[64:67], v27 offset:8192
    s_waitcnt lgkmcnt(2)
    v_mfma_f32_32x32x16_bf16 v[76:91], a[52:55], a[8:11], v[76:91]
    v_exp_f32 v47, v47
    ds_read_b128 a[52:55], v28 offset:0
    v_mfma_f32_32x32x16_bf16 v[92:107], a[56:59], a[8:11], v[92:107]
    v_exp_f32 v48, v48
    v_exp_f32 v49, v49
    ds_read_b128 a[56:59], v28 offset:8192
    s_waitcnt lgkmcnt(2)
    v_mfma_f32_32x32x16_bf16 v[76:91], a[60:63], a[12:15], v[76:91]
    v_exp_f32 v50, v50
    ds_read_b128 a[60:63], v29 offset:0
    v_mfma_f32_32x32x16_bf16 v[92:107], a[64:67], a[12:15], v[92:107]
    v_exp_f32 v51, v51
    v_cvt_pk_bf16_f32 v108, v44, v45
    ds_read_b128 a[64:67], v29 offset:8192
    s_waitcnt lgkmcnt(2)
    v_mfma_f32_32x32x16_bf16 v[76:91], a[52:55], a[16:19], v[76:91]
    v_cvt_pk_bf16_f32 v109, v46, v47
    v_cvt_pk_bf16_f32 v110, v48, v49
    v_cvt_pk_bf16_f32 v111, v50, v51
    ds_read_b128 a[52:55], v30 offset:0
    v_mfma_f32_32x32x16_bf16 v[92:107], a[56:59], a[16:19], v[92:107]
    v_exp_f32 v52, v52
    v_exp_f32 v53, v53
    ds_read_b128 a[56:59], v30 offset:8192
    s_waitcnt lgkmcnt(2)
    v_mfma_f32_32x32x16_bf16 v[76:91], a[60:63], a[20:23], v[76:91]
    v_exp_f32 v54, v54
    ds_read_b128 a[60:63], v31 offset:0
    v_mfma_f32_32x32x16_bf16 v[92:107], a[64:67], a[20:23], v[92:107]
    v_exp_f32 v55, v55
    ds_read_b128 a[64:67], v31 offset:8192
    s_waitcnt lgkmcnt(2)
    v_mfma_f32_32x32x16_bf16 v[76:91], a[52:55], a[24:27], v[76:91]
    v_exp_f32 v56, v56
    v_exp_f32 v57, v57
    v_add_u32 v32, 32768, v32
    v_add_u32 v33, 32768, v33
    v_add_u32 v34, 32768, v34
    v_add_u32 v35, 32768, v35
    ds_read_b64_tr_b16 a[52:53], v32 offset:0
    ds_read_b64_tr_b16 a[54:55], v32 offset:2048
    v_mfma_f32_32x32x16_bf16 v[92:107], a[56:59], a[24:27], v[92:107]
    v_exp_f32 v58, v58
    ds_read_b64_tr_b16 a[56:57], v33 offset:0
    ds_read_b64_tr_b16 a[58:59], v33 offset:2048
    s_waitcnt lgkmcnt(4)
    v_mfma_f32_32x32x16_bf16 v[76:91], a[60:63], a[28:31], v[76:91]
    v_exp_f32 v59, v59
    ds_read_b64_tr_b16 a[60:61], v34 offset:0
    ds_read_b64_tr_b16 a[62:63], v34 offset:2048
    v_mfma_f32_32x32x16_bf16 v[92:107], a[64:67], a[28:31], v[92:107]
    v_cvt_pk_bf16_f32 v112, v52, v53
    ds_read_b64_tr_b16 a[64:65], v35 offset:0
    ds_read_b64_tr_b16 a[66:67], v35 offset:2048
    s_waitcnt lgkmcnt(4)
    v_mfma_f32_32x32x16_bf16 v[124:139], a[52:55], v[108:111], v[124:139]
    v_cvt_pk_bf16_f32 v113, v54, v55
    ds_read_b64_tr_b16 a[52:53], v32 offset:4096
    ds_read_b64_tr_b16 a[54:55], v32 offset:6144
    v_mfma_f32_32x32x16_bf16 v[140:155], a[56:59], v[108:111], v[140:155]
    v_cvt_pk_bf16_f32 v114, v56, v57
    v_cvt_pk_bf16_f32 v115, v58, v59
    ds_read_b64_tr_b16 a[56:57], v33 offset:4096
    ds_read_b64_tr_b16 a[58:59], v33 offset:6144
    s_waitcnt lgkmcnt(4)
    v_mfma_f32_32x32x16_bf16 v[156:171], a[60:63], v[108:111], v[156:171]
    v_exp_f32 v60, v60
    ds_read_b64_tr_b16 a[60:61], v34 offset:4096
    ds_read_b64_tr_b16 a[62:63], v34 offset:6144
    v_mfma_f32_32x32x16_bf16 v[172:187], a[64:67], v[108:111], v[172:187]
    v_mfma_f32_32x32x16_bf16 a[36:51], a[32:35], v[108:111], a[36:51]
    v_exp_f32 v61, v61
    v_exp_f32 v62, v62
    v_exp_f32 v63, v63
    ds_read_b64_tr_b16 a[64:65], v35 offset:4096
    ds_read_b64_tr_b16 a[66:67], v35 offset:6144
    s_waitcnt lgkmcnt(4)
    v_mfma_f32_32x32x16_bf16 v[124:139], a[52:55], v[112:115], v[124:139]
    v_exp_f32 v64, v64
    ds_read_b64_tr_b16 a[52:53], v32 offset:8192
    ds_read_b64_tr_b16 a[54:55], v32 offset:10240
    v_mfma_f32_32x32x16_bf16 v[140:155], a[56:59], v[112:115], v[140:155]
    v_exp_f32 v65, v65
    v_exp_f32 v66, v66
    ds_read_b64_tr_b16 a[56:57], v33 offset:8192
    ds_read_b64_tr_b16 a[58:59], v33 offset:10240
    s_waitcnt lgkmcnt(4)
    v_mfma_f32_32x32x16_bf16 v[156:171], a[60:63], v[112:115], v[156:171]
    v_exp_f32 v67, v67
    ds_read_b64_tr_b16 a[60:61], v34 offset:8192
    ds_read_b64_tr_b16 a[62:63], v34 offset:10240
    v_mfma_f32_32x32x16_bf16 v[172:187], a[64:67], v[112:115], v[172:187]
    v_mfma_f32_32x32x16_bf16 a[36:51], a[32:35], v[112:115], a[36:51]
    v_cvt_pk_bf16_f32 v116, v60, v61
    v_cvt_pk_bf16_f32 v117, v62, v63
    v_cvt_pk_bf16_f32 v118, v64, v65
    v_cvt_pk_bf16_f32 v119, v66, v67
    v_exp_f32 v68, v68
    v_exp_f32 v69, v69
    v_exp_f32 v70, v70
    v_exp_f32 v71, v71
    v_exp_f32 v72, v72
    ds_read_b64_tr_b16 a[64:65], v35 offset:8192
    ds_read_b64_tr_b16 a[66:67], v35 offset:10240
    s_waitcnt lgkmcnt(4)
    v_mfma_f32_32x32x16_bf16 v[124:139], a[52:55], v[116:119], v[124:139]
    v_exp_f32 v73, v73
    ds_read_b64_tr_b16 a[52:53], v32 offset:12288
    ds_read_b64_tr_b16 a[54:55], v32 offset:14336
    v_mfma_f32_32x32x16_bf16 v[140:155], a[56:59], v[116:119], v[140:155]
    ds_read_b64_tr_b16 a[56:57], v33 offset:12288
    ds_read_b64_tr_b16 a[58:59], v33 offset:14336
    s_waitcnt lgkmcnt(4)
    v_mfma_f32_32x32x16_bf16 v[156:171], a[60:63], v[116:119], v[156:171]
    v_exp_f32 v74, v74
    ds_read_b64_tr_b16 a[60:61], v34 offset:12288
    ds_read_b64_tr_b16 a[62:63], v34 offset:14336
    v_mfma_f32_32x32x16_bf16 v[172:187], a[64:67], v[116:119], v[172:187]
    v_mfma_f32_32x32x16_bf16 a[36:51], a[32:35], v[116:119], a[36:51]
    v_exp_f32 v75, v75
    v_cvt_pk_bf16_f32 v120, v68, v69
    v_cvt_pk_bf16_f32 v121, v70, v71
    v_cvt_pk_bf16_f32 v122, v72, v73
    v_cvt_pk_bf16_f32 v123, v74, v75
    v_max3_f32 v39, v76, v77, v78
    v_max3_f32 v40, v79, v80, v81
    ds_read_b64_tr_b16 a[64:65], v35 offset:12288
    ds_read_b64_tr_b16 a[66:67], v35 offset:14336
    s_waitcnt lgkmcnt(4)
    v_mfma_f32_32x32x16_bf16 v[124:139], a[52:55], v[120:123], v[124:139]
    v_max3_f32 v39, v39, v82, v83
    s_barrier
    v_add_u32 v24, 32768, v24
    v_add_u32 v25, 32768, v25
    v_add_u32 v26, 32768, v26
    v_add_u32 v27, 32768, v27
    v_add_u32 v28, 32768, v28
    v_add_u32 v29, 32768, v29
    v_add_u32 v30, 32768, v30
    v_add_u32 v31, 32768, v31
    ds_read_b128 a[52:55], v24 offset:0
    v_mfma_f32_32x32x16_bf16 v[140:155], a[56:59], v[120:123], v[140:155]
    v_max3_f32 v40, v40, v84, v85
    v_max3_f32 v39, v39, v86, v87
    v_max3_f32 v40, v40, v88, v89
    ds_read_b128 a[56:59], v24 offset:8192
    s_waitcnt lgkmcnt(2)
    v_mfma_f32_32x32x16_bf16 v[156:171], a[60:63], v[120:123], v[156:171]
    v_max3_f32 v39, v39, v90, v91
    v_max3_f32 v40, v40, v92, v93
    ds_read_b128 a[60:63], v25 offset:0
    v_mfma_f32_32x32x16_bf16 v[172:187], a[64:67], v[120:123], v[172:187]
    v_mfma_f32_32x32x16_bf16 a[36:51], a[32:35], v[120:123], a[36:51]
    v_max3_f32 v39, v39, v94, v95
    v_max3_f32 v40, v40, v96, v97
    v_max3_f32 v39, v39, v98, v99
    v_max3_f32 v40, v40, v100, v101
    v_max3_f32 v39, v39, v102, v103
    v_max3_f32 v40, v40, v104, v105
    v_max3_f32 v39, v39, v106, v107
    v_max_f32 v39, v39, v40
    v_cmp_gt_f32 vcc, v39, v38
    ds_read_b128 a[64:67], v25 offset:8192
    s_waitcnt lgkmcnt(2)
    v_mfma_f32_32x32x16_bf16 v[44:59], a[52:55], a[0:3], v[8:23]
    ds_read_b128 a[52:55], v26 offset:0
    v_mfma_f32_32x32x16_bf16 v[60:75], a[56:59], a[0:3], v[8:23]
    s_cbranch_vccnz L_resc_4
L_resc_4_back:
    ds_read_b128 a[56:59], v26 offset:8192
    s_waitcnt lgkmcnt(2)
    v_mfma_f32_32x32x16_bf16 v[44:59], a[60:63], a[4:7], v[44:59]
    v_exp_f32 v76, v76
    ds_read_b128 a[60:63], v27 offset:0
    v_mfma_f32_32x32x16_bf16 v[60:75], a[64:67], a[4:7], v[60:75]
    v_exp_f32 v77, v77
    v_exp_f32 v78, v78
    ds_read_b128 a[64:67], v27 offset:8192
    s_waitcnt lgkmcnt(2)
    v_mfma_f32_32x32x16_bf16 v[44:59], a[52:55], a[8:11], v[44:59]
    v_exp_f32 v79, v79
    ds_read_b128 a[52:55], v28 offset:0
    v_mfma_f32_32x32x16_bf16 v[60:75], a[56:59], a[8:11], v[60:75]
    v_exp_f32 v80, v80
    v_exp_f32 v81, v81
    ds_read_b128 a[56:59], v28 offset:8192
    s_waitcnt lgkmcnt(2)
    v_mfma_f32_32x32x16_bf16 v[44:59], a[60:63], a[12:15], v[44:59]
    v_exp_f32 v82, v82
    ds_read_b128 a[60:63], v29 offset:0
    v_mfma_f32_32x32x16_bf16 v[60:75], a[64:67], a[12:15], v[60:75]
    v_exp_f32 v83, v83
    v_cvt_pk_bf16_f32 v108, v76, v77
    ds_read_b128 a[64:67], v29 offset:8192
    s_waitcnt lgkmcnt(2)
    v_mfma_f32_32x32x16_bf16 v[44:59], a[52:55], a[16:19], v[44:59]
    v_cvt_pk_bf16_f32 v109, v78, v79
    v_cvt_pk_bf16_f32 v110, v80, v81
    v_cvt_pk_bf16_f32 v111, v82, v83
    ds_read_b128 a[52:55], v30 offset:0
    v_mfma_f32_32x32x16_bf16 v[60:75], a[56:59], a[16:19], v[60:75]
    v_exp_f32 v84, v84
    v_exp_f32 v85, v85
    ds_read_b128 a[56:59], v30 offset:8192
    s_waitcnt lgkmcnt(2)
    v_mfma_f32_32x32x16_bf16 v[44:59], a[60:63], a[20:23], v[44:59]
    v_exp_f32 v86, v86
    ds_read_b128 a[60:63], v31 offset:0
    v_mfma_f32_32x32x16_bf16 v[60:75], a[64:67], a[20:23], v[60:75]
    v_exp_f32 v87, v87
    ds_read_b128 a[64:67], v31 offset:8192
    s_waitcnt lgkmcnt(2)
    v_mfma_f32_32x32x16_bf16 v[44:59], a[52:55], a[24:27], v[44:59]
    v_exp_f32 v88, v88
    v_exp_f32 v89, v89
    s_barrier
    v_add_u32 v32, 32768, v32
    v_add_u32 v33, 32768, v33
    v_add_u32 v34, 32768, v34
    v_add_u32 v35, 32768, v35
    ds_read_b64_tr_b16 a[52:53], v32 offset:0
    ds_read_b64_tr_b16 a[54:55], v32 offset:2048
    v_mfma_f32_32x32x16_bf16 v[60:75], a[56:59], a[24:27], v[60:75]
    v_exp_f32 v90, v90
    ds_read_b64_tr_b16 a[56:57], v33 offset:0
    ds_read_b64_tr_b16 a[58:59], v33 offset:2048
    s_waitcnt lgkmcnt(4)
    v_mfma_f32_32x32x16_bf16 v[44:59], a[60:63], a[28:31], v[44:59]
    v_exp_f32 v91, v91
    ds_read_b64_tr_b16 a[60:61], v34 offset:0
    ds_read_b64_tr_b16 a[62:63], v34 offset:2048
    v_mfma_f32_32x32x16_bf16 v[60:75], a[64:67], a[28:31], v[60:75]
    v_cvt_pk_bf16_f32 v112, v84, v85
    ds_read_b64_tr_b16 a[64:65], v35 offset:0
    ds_read_b64_tr_b16 a[66:67], v35 offset:2048
    s_waitcnt lgkmcnt(4)
    v_mfma_f32_32x32x16_bf16 v[124:139], a[52:55], v[108:111], v[124:139]
    v_cvt_pk_bf16_f32 v113, v86, v87
    ds_read_b64_tr_b16 a[52:53], v32 offset:4096
    ds_read_b64_tr_b16 a[54:55], v32 offset:6144
    v_mfma_f32_32x32x16_bf16 v[140:155], a[56:59], v[108:111], v[140:155]
    v_cvt_pk_bf16_f32 v114, v88, v89
    v_cvt_pk_bf16_f32 v115, v90, v91
    ds_read_b64_tr_b16 a[56:57], v33 offset:4096
    ds_read_b64_tr_b16 a[58:59], v33 offset:6144
    s_waitcnt lgkmcnt(4)
    v_mfma_f32_32x32x16_bf16 v[156:171], a[60:63], v[108:111], v[156:171]
    v_exp_f32 v92, v92
    ds_read_b64_tr_b16 a[60:61], v34 offset:4096
    ds_read_b64_tr_b16 a[62:63], v34 offset:6144
    v_mfma_f32_32x32x16_bf16 v[172:187], a[64:67], v[108:111], v[172:187]
    v_mfma_f32_32x32x16_bf16 a[36:51], a[32:35], v[108:111], a[36:51]
    v_exp_f32 v93, v93
    v_exp_f32 v94, v94
    v_exp_f32 v95, v95
    ds_read_b64_tr_b16 a[64:65], v35 offset:4096
    ds_read_b64_tr_b16 a[66:67], v35 offset:6144
    s_waitcnt lgkmcnt(4)
    v_mfma_f32_32x32x16_bf16 v[124:139], a[52:55], v[112:115], v[124:139]
    v_exp_f32 v96, v96
    ds_read_b64_tr_b16 a[52:53], v32 offset:8192
    ds_read_b64_tr_b16 a[54:55], v32 offset:10240
    v_mfma_f32_32x32x16_bf16 v[140:155], a[56:59], v[112:115], v[140:155]
    v_exp_f32 v97, v97
    v_exp_f32 v98, v98
    ds_read_b64_tr_b16 a[56:57], v33 offset:8192
    ds_read_b64_tr_b16 a[58:59], v33 offset:10240
    s_waitcnt lgkmcnt(4)
    v_mfma_f32_32x32x16_bf16 v[156:171], a[60:63], v[112:115], v[156:171]
    v_exp_f32 v99, v99
    ds_read_b64_tr_b16 a[60:61], v34 offset:8192
    ds_read_b64_tr_b16 a[62:63], v34 offset:10240
    v_mfma_f32_32x32x16_bf16 v[172:187], a[64:67], v[112:115], v[172:187]
    v_mfma_f32_32x32x16_bf16 a[36:51], a[32:35], v[112:115], a[36:51]
    v_cvt_pk_bf16_f32 v116, v92, v93
    v_cvt_pk_bf16_f32 v117, v94, v95
    v_cvt_pk_bf16_f32 v118, v96, v97
    v_cvt_pk_bf16_f32 v119, v98, v99
    v_exp_f32 v100, v100
    v_exp_f32 v101, v101
    v_exp_f32 v102, v102
    v_exp_f32 v103, v103
    v_exp_f32 v104, v104
    ds_read_b64_tr_b16 a[64:65], v35 offset:8192
    ds_read_b64_tr_b16 a[66:67], v35 offset:10240
    s_waitcnt lgkmcnt(4)
    v_mfma_f32_32x32x16_bf16 v[124:139], a[52:55], v[116:119], v[124:139]
    v_exp_f32 v105, v105
    ds_read_b64_tr_b16 a[52:53], v32 offset:12288
    ds_read_b64_tr_b16 a[54:55], v32 offset:14336
    v_mfma_f32_32x32x16_bf16 v[140:155], a[56:59], v[116:119], v[140:155]
    ds_read_b64_tr_b16 a[56:57], v33 offset:12288
    ds_read_b64_tr_b16 a[58:59], v33 offset:14336
    s_waitcnt lgkmcnt(4)
    v_mfma_f32_32x32x16_bf16 v[156:171], a[60:63], v[116:119], v[156:171]
    v_exp_f32 v106, v106
    ds_read_b64_tr_b16 a[60:61], v34 offset:12288
    ds_read_b64_tr_b16 a[62:63], v34 offset:14336
    v_mfma_f32_32x32x16_bf16 v[172:187], a[64:67], v[116:119], v[172:187]
    v_mfma_f32_32x32x16_bf16 a[36:51], a[32:35], v[116:119], a[36:51]
    v_exp_f32 v107, v107
    v_cvt_pk_bf16_f32 v120, v100, v101
    v_cvt_pk_bf16_f32 v121, v102, v103
    v_cvt_pk_bf16_f32 v122, v104, v105
    v_cvt_pk_bf16_f32 v123, v106, v107
    v_max3_f32 v39, v44, v45, v46
    v_max3_f32 v40, v47, v48, v49
    ds_read_b64_tr_b16 a[64:65], v35 offset:12288
    ds_read_b64_tr_b16 a[66:67], v35 offset:14336
    s_waitcnt lgkmcnt(4)
    v_mfma_f32_32x32x16_bf16 v[124:139], a[52:55], v[120:123], v[124:139]
    v_mov_b32 v3, s79
    global_load_dwordx4 v[4:7], v3, s[18:19] sc1
    v_max3_f32 v39, v39, v50, v51
    s_barrier
    v_add_u32 v24, 32768, v24
    v_add_u32 v25, 32768, v25
    v_add_u32 v26, 32768, v26
    v_add_u32 v27, 32768, v27
    v_add_u32 v28, 32768, v28
    v_add_u32 v29, 32768, v29
    v_add_u32 v30, 32768, v30
    v_add_u32 v31, 32768, v31
    ds_read_b128 a[52:55], v24 offset:0
    v_mfma_f32_32x32x16_bf16 v[140:155], a[56:59], v[120:123], v[140:155]
    v_max3_f32 v40, v40, v52, v53
    v_max3_f32 v39, v39, v54, v55
    v_max3_f32 v40, v40, v56, v57
    ds_read_b128 a[56:59], v24 offset:8192
    s_waitcnt lgkmcnt(2)
    v_mfma_f32_32x32x16_bf16 v[156:171], a[60:63], v[120:123], v[156:171]
    v_max3_f32 v39, v39, v58, v59
    v_max3_f32 v40, v40, v60, v61
    ds_read_b128 a[60:63], v25 offset:0
    v_mfma_f32_32x32x16_bf16 v[172:187], a[64:67], v[120:123], v[172:187]
    v_mfma_f32_32x32x16_bf16 a[36:51], a[32:35], v[120:123], a[36:51]
    v_max3_f32 v39, v39, v62, v63
    v_max3_f32 v40, v40, v64, v65
    v_max3_f32 v39, v39, v66, v67
    v_max3_f32 v40, v40, v68, v69
    v_max3_f32 v39, v39, v70, v71
    v_max3_f32 v40, v40, v72, v73
    v_max3_f32 v39, v39, v74, v75
    v_max_f32 v39, v39, v40
    v_cmp_gt_f32 vcc, v39, v38
    ds_read_b128 a[64:67], v25 offset:8192
    s_waitcnt lgkmcnt(2)
    v_mfma_f32_32x32x16_bf16 v[76:91], a[52:55], a[0:3], v[8:23]
    ds_read_b128 a[52:55], v26 offset:0
    v_mfma_f32_32x32x16_bf16 v[92:107], a[56:59], a[0:3], v[8:23]
    s_cbranch_vccnz L_resc_5
L_resc_5_back:
    ds_read_b128 a[56:59], v26 offset:8192
    s_waitcnt lgkmcnt(2)
    v_mfma_f32_32x32x16_bf16 v[76:91], a[60:63], a[4:7], v[76:91]
    v_exp_f32 v44, v44
    ds_read_b128 a[60:63], v27 offset:0
    v_mfma_f32_32x32x16_bf16 v[92:107], a[64:67], a[4:7], v[92:107]
    v_exp_f32 v45, v45
    v_exp_f32 v46, v46
    ds_read_b128 a[64:67], v27 offset:8192
    s_waitcnt lgkmcnt(2)
    v_mfma_f32_32x32x16_bf16 v[76:91], a[52:55], a[8:11], v[76:91]
    v_exp_f32 v47, v47
    ds_read_b128 a[52:55], v28 offset:0
    v_mfma_f32_32x32x16_bf16 v[92:107], a[56:59], a[8:11], v[92:107]
    v_exp_f32 v48, v48
    v_exp_f32 v49, v49
    ds_read_b128 a[56:59], v28 offset:8192
    s_waitcnt lgkmcnt(2)
    v_mfma_f32_32x32x16_bf16 v[76:91], a[60:63], a[12:15], v[76:91]
    v_exp_f32 v50, v50
    ds_read_b128 a[60:63], v29 offset:0
    v_mfma_f32_32x32x16_bf16 v[92:107], a[64:67], a[12:15], v[92:107]
    v_exp_f32 v51, v51
    v_cvt_pk_bf16_f32 v108, v44, v45
    ds_read_b128 a[64:67], v29 offset:8192
    s_waitcnt lgkmcnt(2)
    v_mfma_f32_32x32x16_bf16 v[76:91], a[52:55], a[16:19], v[76:91]
    v_cvt_pk_bf16_f32 v109, v46, v47
    v_cvt_pk_bf16_f32 v110, v48, v49
    v_cvt_pk_bf16_f32 v111, v50, v51
    ds_read_b128 a[52:55], v30 offset:0
    v_mfma_f32_32x32x16_bf16 v[92:107], a[56:59], a[16:19], v[92:107]
    v_exp_f32 v52, v52
    v_exp_f32 v53, v53
    ds_read_b128 a[56:59], v30 offset:8192
    s_waitcnt lgkmcnt(2)
    v_mfma_f32_32x32x16_bf16 v[76:91], a[60:63], a[20:23], v[76:91]
    v_exp_f32 v54, v54
    ds_read_b128 a[60:63], v31 offset:0
    v_mfma_f32_32x32x16_bf16 v[92:107], a[64:67], a[20:23], v[92:107]
    v_exp_f32 v55, v55
    ds_read_b128 a[64:67], v31 offset:8192
    s_waitcnt lgkmcnt(2)
    v_mfma_f32_32x32x16_bf16 v[76:91], a[52:55], a[24:27], v[76:91]
    v_exp_f32 v56, v56
    v_exp_f32 v57, v57
    s_barrier
    v_subrev_u32 v32, 32768, v32
    v_subrev_u32 v33, 32768, v33
    v_subrev_u32 v34, 32768, v34
    v_subrev_u32 v35, 32768, v35
    ds_read_b64_tr_b16 a[52:53], v32 offset:0
    ds_read_b64_tr_b16 a[54:55], v32 offset:2048
    v_mfma_f32_32x32x16_bf16 v[92:107], a[56:59], a[24:27], v[92:107]
    v_exp_f32 v58, v58
    ds_read_b64_tr_b16 a[56:57], v33 offset:0
    ds_read_b64_tr_b16 a[58:59], v33 offset:2048
    s_waitcnt lgkmcnt(4)
    v_mfma_f32_32x32x16_bf16 v[76:91], a[60:63], a[28:31], v[76:91]
    v_exp_f32 v59, v59
    ds_read_b64_tr_b16 a[60:61], v34 offset:0
    ds_read_b64_tr_b16 a[62:63], v34 offset:2048
    v_mfma_f32_32x32x16_bf16 v[92:107], a[64:67], a[28:31], v[92:107]
    v_cvt_pk_bf16_f32 v112, v52, v53
    ds_read_b64_tr_b16 a[64:65], v35 offset:0
    ds_read_b64_tr_b16 a[66:67], v35 offset:2048
    s_waitcnt lgkmcnt(4)
    v_mfma_f32_32x32x16_bf16 v[124:139], a[52:55], v[108:111], v[124:139]
    v_cvt_pk_bf16_f32 v113, v54, v55
    ds_read_b64_tr_b16 a[52:53], v32 offset:4096
    ds_read_b64_tr_b16 a[54:55], v32 offset:6144
    v_mfma_f32_32x32x16_bf16 v[140:155], a[56:59], v[108:111], v[140:155]
    v_cvt_pk_bf16_f32 v114, v56, v57
    v_cvt_pk_bf16_f32 v115, v58, v59
    ds_read_b64_tr_b16 a[56:57], v33 offset:4096
    ds_read_b64_tr_b16 a[58:59], v33 offset:6144
    s_waitcnt lgkmcnt(4)
    v_mfma_f32_32x32x16_bf16 v[156:171], a[60:63], v[108:111], v[156:171]
    v_exp_f32 v60, v60
    ds_read_b64_tr_b16 a[60:61], v34 offset:4096
    ds_read_b64_tr_b16 a[62:63], v34 offset:6144
    v_mfma_f32_32x32x16_bf16 v[172:187], a[64:67], v[108:111], v[172:187]
    v_mfma_f32_32x32x16_bf16 a[36:51], a[32:35], v[108:111], a[36:51]
    v_exp_f32 v61, v61
    v_exp_f32 v62, v62
    v_exp_f32 v63, v63
    ds_read_b64_tr_b16 a[64:65], v35 offset:4096
    ds_read_b64_tr_b16 a[66:67], v35 offset:6144
    s_waitcnt lgkmcnt(4)
    v_mfma_f32_32x32x16_bf16 v[124:139], a[52:55], v[112:115], v[124:139]
    v_exp_f32 v64, v64
    ds_read_b64_tr_b16 a[52:53], v32 offset:8192
    ds_read_b64_tr_b16 a[54:55], v32 offset:10240
    v_mfma_f32_32x32x16_bf16 v[140:155], a[56:59], v[112:115], v[140:155]
    v_exp_f32 v65, v65
    v_exp_f32 v66, v66
    ds_read_b64_tr_b16 a[56:57], v33 offset:8192
    ds_read_b64_tr_b16 a[58:59], v33 offset:10240
    s_waitcnt lgkmcnt(4)
    v_mfma_f32_32x32x16_bf16 v[156:171], a[60:63], v[112:115], v[156:171]
    v_exp_f32 v67, v67
    s_or_b32 s65, s70, s26
    ds_read_b64_tr_b16 a[60:61], v34 offset:8192
    ds_read_b64_tr_b16 a[62:63], v34 offset:10240
    v_mfma_f32_32x32x16_bf16 v[172:187], a[64:67], v[112:115], v[172:187]
    v_mfma_f32_32x32x16_bf16 a[36:51], a[32:35], v[112:115], a[36:51]
    v_cvt_pk_bf16_f32 v116, v60, v61
    v_cvt_pk_bf16_f32 v117, v62, v63
    v_cvt_pk_bf16_f32 v118, v64, v65
    v_cvt_pk_bf16_f32 v119, v66, v67
    v_exp_f32 v68, v68
    v_exp_f32 v69, v69
    v_exp_f32 v70, v70
    v_exp_f32 v71, v71
    v_exp_f32 v72, v72
    s_waitcnt vmcnt(0)
    v_xor_b32 v4, s65, v4
    ds_read_b64_tr_b16 a[64:65], v35 offset:8192
    ds_read_b64_tr_b16 a[66:67], v35 offset:10240
    s_waitcnt lgkmcnt(4)
    v_mfma_f32_32x32x16_bf16 v[124:139], a[52:55], v[116:119], v[124:139]
    v_exp_f32 v73, v73
    ds_read_b64_tr_b16 a[52:53], v32 offset:12288
    ds_read_b64_tr_b16 a[54:55], v32 offset:14336
    v_mfma_f32_32x32x16_bf16 v[140:155], a[56:59], v[116:119], v[140:155]
    v_xor_b32 v5, s65, v5
    ds_read_b64_tr_b16 a[56:57], v33 offset:12288
    ds_read_b64_tr_b16 a[58:59], v33 offset:14336
    s_waitcnt lgkmcnt(4)
    v_mfma_f32_32x32x16_bf16 v[156:171], a[60:63], v[116:119], v[156:171]
    v_exp_f32 v74, v74
    v_xor_b32 v6, s65, v6
    ds_read_b64_tr_b16 a[60:61], v34 offset:12288
    ds_read_b64_tr_b16 a[62:63], v34 offset:14336
    v_mfma_f32_32x32x16_bf16 v[172:187], a[64:67], v[116:119], v[172:187]
    v_mfma_f32_32x32x16_bf16 a[36:51], a[32:35], v[116:119], a[36:51]
    v_exp_f32 v75, v75
    v_cvt_pk_bf16_f32 v120, v68, v69
    v_cvt_pk_bf16_f32 v121, v70, v71
    v_cvt_pk_bf16_f32 v122, v72, v73
    v_cvt_pk_bf16_f32 v123, v74, v75
    v_max3_f32 v39, v76, v77, v78
    v_max3_f32 v40, v79, v80, v81
    ds_read_b64_tr_b16 a[64:65], v35 offset:12288
    ds_read_b64_tr_b16 a[66:67], v35 offset:14336
    s_waitcnt lgkmcnt(4)
    v_mfma_f32_32x32x16_bf16 v[124:139], a[52:55], v[120:123], v[124:139]
    v_max3_f32 v39, v39, v82, v83
    v_xor_b32 v7, s65, v7
    s_barrier
    v_subrev_u32 v24, 32768, v24
    v_subrev_u32 v25, 32768, v25
    v_subrev_u32 v26, 32768, v26
    v_subrev_u32 v27, 32768, v27
    v_subrev_u32 v28, 32768, v28
    v_subrev_u32 v29, 32768, v29
    v_subrev_u32 v30, 32768, v30
    v_subrev_u32 v31, 32768, v31
    ds_read_b128 a[52:55], v24 offset:0
    v_mfma_f32_32x32x16_bf16 v[140:155], a[56:59], v[120:123], v[140:155]
    v_max3_f32 v40, v40, v84, v85
    v_max3_f32 v39, v39, v86, v87
    v_max3_f32 v40, v40, v88, v89
    ds_read_b128 a[56:59], v24 offset:8192
    s_waitcnt lgkmcnt(2)
    v_mfma_f32_32x32x16_bf16 v[156:171], a[60:63], v[120:123], v[156:171]
    v_max3_f32 v39, v39, v90, v91
    v_max3_f32 v40, v40, v92, v93
    v_or_b32 v4, v4, v5
    ds_read_b128 a[60:63], v25 offset:0
    v_mfma_f32_32x32x16_bf16 v[172:187], a[64:67], v[120:123], v[172:187]
    v_mfma_f32_32x32x16_bf16 a[36:51], a[32:35], v[120:123], a[36:51]
    v_max3_f32 v39, v39, v94, v95
    v_max3_f32 v40, v40, v96, v97
    v_max3_f32 v39, v39, v98, v99
    v_max3_f32 v40, v40, v100, v101
    v_max3_f32 v39, v39, v102, v103
    v_max3_f32 v40, v40, v104, v105
    v_max3_f32 v39, v39, v106, v107
    v_max_f32 v39, v39, v40
    v_cmp_gt_f32 vcc, v39, v38
    v_or_b32 v6, v6, v7
    ds_read_b128 a[64:67], v25 offset:8192
    s_waitcnt lgkmcnt(2)
    v_mfma_f32_32x32x16_bf16 v[44:59], a[52:55], a[0:3], v[8:23]
    ds_read_b128 a[52:55], v26 offset:0
    v_mfma_f32_32x32x16_bf16 v[60:75], a[56:59], a[0:3], v[8:23]
    s_cbranch_vccnz L_resc_6
L_resc_6_back:
    v_or_b32 v4, v4, v6
    ds_read_b128 a[56:59], v26 offset:8192
    s_waitcnt lgkmcnt(2)
    v_mfma_f32_32x32x16_bf16 v[44:59], a[60:63], a[4:7], v[44:59]
    v_exp_f32 v76, v76
    v_readfirstlane_b32 s27, v4
    ds_read_b128 a[60:63], v27 offset:0
    v_mfma_f32_32x32x16_bf16 v[60:75], a[64:67], a[4:7], v[60:75]
    v_exp_f32 v77, v77
    v_exp_f32 v78, v78
    ds_read_b128 a[64:67], v27 offset:8192
    s_waitcnt lgkmcnt(2)
    v_mfma_f32_32x32x16_bf16 v[44:59], a[52:55], a[8:11], v[44:59]
    v_exp_f32 v79, v79
    v_lshlrev_b32 v4, 4, v1
    ds_read_b128 a[52:55], v28 offset:0
    v_mfma_f32_32x32x16_bf16 v[60:75], a[56:59], a[8:11], v[60:75]
    v_exp_f32 v80, v80
    v_exp_f32 v81, v81
    ds_read_b128 a[56:59], v28 offset:8192
    s_waitcnt lgkmcnt(2)
    v_mfma_f32_32x32x16_bf16 v[44:59], a[60:63], a[12:15], v[44:59]
    v_exp_f32 v82, v82
    s_lshl_b32 s65, s22, 13
    ds_read_b128 a[60:63], v29 offset:0
    v_mfma_f32_32x32x16_bf16 v[60:75], a[64:67], a[12:15], v[60:75]
    v_exp_f32 v83, v83
    v_cvt_pk_bf16_f32 v108, v76, v77
    s_add_u32 s66, s65, 4096
    ds_read_b128 a[64:67], v29 offset:8192
    s_waitcnt lgkmcnt(2)
    v_mfma_f32_32x32x16_bf16 v[44:59], a[52:55], a[16:19], v[44:59]
    v_cvt_pk_bf16_f32 v109, v78, v79
    v_cvt_pk_bf16_f32 v110, v80, v81
    v_cvt_pk_bf16_f32 v111, v82, v83
    ds_read_b128 a[52:55], v30 offset:0
    v_mfma_f32_32x32x16_bf16 v[60:75], a[56:59], a[16:19], v[60:75]
    v_exp_f32 v84, v84
    v_exp_f32 v85, v85
    s_lshl_b32 s67, s23, 3
    ds_read_b128 a[56:59], v30 offset:8192
    s_waitcnt lgkmcnt(2)
    v_mfma_f32_32x32x16_bf16 v[44:59], a[60:63], a[20:23], v[44:59]
    v_exp_f32 v86, v86
    s_add_u32 s67, s67, s21
    ds_read_b128 a[60:63], v31 offset:0
    v_mfma_f32_32x32x16_bf16 v[60:75], a[64:67], a[20:23], v[60:75]
    v_exp_f32 v87, v87
    ds_read_b128 a[64:67], v31 offset:8192
    s_waitcnt lgkmcnt(2)
    v_mfma_f32_32x32x16_bf16 v[44:59], a[52:55], a[24:27], v[44:59]
    v_exp_f32 v88, v88
    v_exp_f32 v89, v89
    s_lshl_b32 s67, s67, 2
    s_barrier
    v_add_u32 v32, 32768, v32
    v_add_u32 v33, 32768, v33
    v_add_u32 v34, 32768, v34
    v_add_u32 v35, 32768, v35
    ds_read_b64_tr_b16 a[52:53], v32 offset:0
    ds_read_b64_tr_b16 a[54:55], v32 offset:2048
    v_mfma_f32_32x32x16_bf16 v[60:75], a[56:59], a[24:27], v[60:75]
    v_exp_f32 v90, v90
    ds_read_b64_tr_b16 a[56:57], v33 offset:0
    ds_read_b64_tr_b16 a[58:59], v33 offset:2048
    s_waitcnt lgkmcnt(4)
    v_mfma_f32_32x32x16_bf16 v[44:59], a[60:63], a[28:31], v[44:59]
    v_exp_f32 v91, v91
    s_add_u32 s67, s67, s20
    ds_read_b64_tr_b16 a[60:61], v34 offset:0
    ds_read_b64_tr_b16 a[62:63], v34 offset:2048
    v_mfma_f32_32x32x16_bf16 v[60:75], a[64:67], a[28:31], v[60:75]
    v_cvt_pk_bf16_f32 v112, v84, v85
    s_lshl_b32 s67, s67, 6
    ds_read_b64_tr_b16 a[64:65], v35 offset:0
    ds_read_b64_tr_b16 a[66:67], v35 offset:2048
    s_waitcnt lgkmcnt(4)
    v_mfma_f32_32x32x16_bf16 v[124:139], a[52:55], v[108:111], v[124:139]
    v_cvt_pk_bf16_f32 v113, v86, v87
    ds_read_b64_tr_b16 a[52:53], v32 offset:4096
    ds_read_b64_tr_b16 a[54:55], v32 offset:6144
    v_mfma_f32_32x32x16_bf16 v[140:155], a[56:59], v[108:111], v[140:155]
    v_cvt_pk_bf16_f32 v114, v88, v89
    v_cvt_pk_bf16_f32 v115, v90, v91
    s_add_u32 s67, s67, 33554432
    ds_read_b64_tr_b16 a[56:57], v33 offset:4096
    ds_read_b64_tr_b16 a[58:59], v33 offset:6144
    s_waitcnt lgkmcnt(4)
    v_mfma_f32_32x32x16_bf16 v[156:171], a[60:63], v[108:111], v[156:171]
    v_exp_f32 v92, v92
    s_lshl_b32 s68, s22, 2
    ds_read_b64_tr_b16 a[60:61], v34 offset:4096
    ds_read_b64_tr_b16 a[62:63], v34 offset:6144
    v_mfma_f32_32x32x16_bf16 v[172:187], a[64:67], v[108:111], v[172:187]
    v_mfma_f32_32x32x16_bf16 a[36:51], a[32:35], v[108:111], a[36:51]
    v_exp_f32 v93, v93
    v_exp_f32 v94, v94
    v_exp_f32 v95, v95
    ds_read_b64_tr_b16 a[64:65], v35 offset:4096
    ds_read_b64_tr_b16 a[66:67], v35 offset:6144
    s_waitcnt lgkmcnt(4)
    v_mfma_f32_32x32x16_bf16 v[124:139], a[52:55], v[112:115], v[124:139]
    v_exp_f32 v96, v96
    v_mov_b32 v5, s67
    ds_read_b64_tr_b16 a[52:53], v32 offset:8192
    ds_read_b64_tr_b16 a[54:55], v32 offset:10240
    v_mfma_f32_32x32x16_bf16 v[140:155], a[56:59], v[112:115], v[140:155]
    v_exp_f32 v97, v97
    v_exp_f32 v98, v98
    ds_read_b64_tr_b16 a[56:57], v33 offset:8192
    ds_read_b64_tr_b16 a[58:59], v33 offset:10240
    s_waitcnt lgkmcnt(4)
    v_mfma_f32_32x32x16_bf16 v[156:171], a[60:63], v[112:115], v[156:171]
    v_exp_f32 v99, v99
    v_add_u32 v6, s68, v5
    ds_read_b64_tr_b16 a[60:61], v34 offset:8192
    ds_read_b64_tr_b16 a[62:63], v34 offset:10240
    v_mfma_f32_32x32x16_bf16 v[172:187], a[64:67], v[112:115], v[172:187]
    v_mfma_f32_32x32x16_bf16 a[36:51], a[32:35], v[112:115], a[36:51]
    v_cvt_pk_bf16_f32 v116, v92, v93
    v_cvt_pk_bf16_f32 v117, v94, v95
    v_cvt_pk_bf16_f32 v118, v96, v97
    v_cvt_pk_bf16_f32 v119, v98, v99
    v_exp_f32 v100, v100
    v_exp_f32 v101, v101
    v_exp_f32 v102, v102
    v_exp_f32 v103, v103
    v_exp_f32 v104, v104
    v_mov_b32 v7, s70
    ds_read_b64_tr_b16 a[64:65], v35 offset:8192
    ds_read_b64_tr_b16 a[66:67], v35 offset:10240
    s_waitcnt lgkmcnt(4)
    v_mfma_f32_32x32x16_bf16 v[124:139], a[52:55], v[116:119], v[124:139]
    v_exp_f32 v105, v105
    ds_read_b64_tr_b16 a[52:53], v32 offset:12288
    ds_read_b64_tr_b16 a[54:55], v32 offset:14336
    v_mfma_f32_32x32x16_bf16 v[140:155], a[56:59], v[116:119], v[140:155]
    v_and_b32 v42, 3, v1
    ds_read_b64_tr_b16 a[56:57], v33 offset:12288
    ds_read_b64_tr_b16 a[58:59], v33 offset:14336
    s_waitcnt lgkmcnt(4)
    v_mfma_f32_32x32x16_bf16 v[156:171], a[60:63], v[116:119], v[156:171]
    v_exp_f32 v106, v106
    v_lshlrev_b32 v42, 2, v42
    ds_read_b64_tr_b16 a[60:61], v34 offset:12288
    ds_read_b64_tr_b16 a[62:63], v34 offset:14336
    v_mfma_f32_32x32x16_bf16 v[172:187], a[64:67], v[116:119], v[172:187]
    v_mfma_f32_32x32x16_bf16 a[36:51], a[32:35], v[116:119], a[36:51]
    v_exp_f32 v107, v107
    v_cvt_pk_bf16_f32 v120, v100, v101
    v_cvt_pk_bf16_f32 v121, v102, v103
    v_cvt_pk_bf16_f32 v122, v104, v105
    v_cvt_pk_bf16_f32 v123, v106, v107
    v_max3_f32 v39, v44, v45, v46
    ds_read_b64_tr_b16 a[64:65], v35 offset:12288
    ds_read_b64_tr_b16 a[66:67], v35 offset:14336
    s_waitcnt lgkmcnt(4)
    v_mfma_f32_32x32x16_bf16 v[124:139], a[52:55], v[120:123], v[124:139]
    v_max3_f32 v40, v47, v48, v49
    v_add_u32 v5, v5, v42
    v_mfma_f32_32x32x16_bf16 v[140:155], a[56:59], v[120:123], v[140:155]
    v_max3_f32 v39, v39, v50, v51
    v_max3_f32 v40, v40, v52, v53
    v_max3_f32 v39, v39, v54, v55
    v_max3_f32 v40, v40, v56, v57
    s_waitcnt lgkmcnt(0)
    v_mfma_f32_32x32x16_bf16 v[156:171], a[60:63], v[120:123], v[156:171]
    v_max3_f32 v39, v39, v58, v59
    v_max3_f32 v40, v40, v60, v61
    v_max3_f32 v39, v39, v62, v63
    v_mfma_f32_32x32x16_bf16 v[172:187], a[64:67], v[120:123], v[172:187]
    v_mfma_f32_32x32x16_bf16 a[36:51], a[32:35], v[120:123], a[36:51]
    v_max3_f32 v40, v40, v64, v65
    v_max3_f32 v39, v39, v66, v67
    v_max3_f32 v40, v40, v68, v69
    v_max3_f32 v39, v39, v70, v71
    v_max3_f32 v40, v40, v72, v73
    v_max3_f32 v39, v39, v74, v75
    v_max_f32 v39, v39, v40
    v_cmp_gt_f32 vcc, v39, v38
    s_nop 3
    s_cbranch_vccnz L_resc_7
L_resc_7_back:
    v_exp_f32 v44, v44
    v_exp_f32 v45, v45
    v_exp_f32 v46, v46
    v_exp_f32 v47, v47
    v_exp_f32 v48, v48
    v_exp_f32 v49, v49
    v_exp_f32 v50, v50
    v_exp_f32 v51, v51
    v_cvt_pk_bf16_f32 v108, v44, v45
    v_cvt_pk_bf16_f32 v109, v46, v47
    v_cvt_pk_bf16_f32 v110, v48, v49
    v_cvt_pk_bf16_f32 v111, v50, v51
    v_exp_f32 v52, v52
    v_exp_f32 v53, v53
    v_exp_f32 v54, v54
    v_exp_f32 v55, v55
    v_exp_f32 v56, v56
    v_exp_f32 v57, v57
    v_exp_f32 v58, v58
    v_exp_f32 v59, v59
    v_cvt_pk_bf16_f32 v112, v52, v53
    v_cvt_pk_bf16_f32 v113, v54, v55
    v_cvt_pk_bf16_f32 v114, v56, v57
    v_cvt_pk_bf16_f32 v115, v58, v59
    v_exp_f32 v60, v60
    v_exp_f32 v61, v61
    v_exp_f32 v62, v62
    v_exp_f32 v63, v63
    v_exp_f32 v64, v64
    v_exp_f32 v65, v65
    v_exp_f32 v66, v66
    v_exp_f32 v67, v67
    v_cvt_pk_bf16_f32 v116, v60, v61
    v_cvt_pk_bf16_f32 v117, v62, v63
    v_cvt_pk_bf16_f32 v118, v64, v65
    v_cvt_pk_bf16_f32 v119, v66, v67
    v_exp_f32 v68, v68
    v_exp_f32 v69, v69
    v_exp_f32 v70, v70
    v_exp_f32 v71, v71
    v_exp_f32 v72, v72
    v_exp_f32 v73, v73
    v_exp_f32 v74, v74
    v_exp_f32 v75, v75
    v_cvt_pk_bf16_f32 v120, v68, v69
    v_cvt_pk_bf16_f32 v121, v70, v71
    v_cvt_pk_bf16_f32 v122, v72, v73
    v_cvt_pk_bf16_f32 v123, v74, v75
    v_mfma_f32_32x32x16_bf16 a[36:51], a[32:35], v[108:111], a[36:51]
    v_mfma_f32_32x32x16_bf16 a[36:51], a[32:35], v[112:115], a[36:51]
    v_mfma_f32_32x32x16_bf16 a[36:51], a[32:35], v[116:119], a[36:51]
    v_mfma_f32_32x32x16_bf16 a[36:51], a[32:35], v[120:123], a[36:51]
    s_nop 11
    v_accvgpr_read_b32 v42, a36
    v_rcp_f32 v42, v42
    s_nop 0
    v_mov_b32 v43, v42
    s_cmp_lg_u32 s27, 0
    s_cbranch_scc1 L_own_slow
    s_barrier
    v_add_u32 v32, 16384, v32
    v_add_u32 v33, 16384, v33
    v_add_u32 v34, 16384, v34
    v_add_u32 v35, 16384, v35
    ds_read_b64_tr_b16 a[52:53], v32 offset:0
    ds_read_b64_tr_b16 a[54:55], v32 offset:2048
    ds_read_b64_tr_b16 a[56:57], v32 offset:4096
    ds_read_b64_tr_b16 a[58:59], v32 offset:6144
    ds_read_b64_tr_b16 a[60:61], v32 offset:8192
    ds_read_b64_tr_b16 a[62:63], v32 offset:10240
    ds_read_b64_tr_b16 a[64:65], v32 offset:12288
    ds_read_b64_tr_b16 a[66:67], v32 offset:14336
    s_waitcnt lgkmcnt(4)
    v_mfma_f32_32x32x16_bf16 v[124:139], a[52:55], v[108:111], v[124:139]
    ds_read_b64_tr_b16 a[52:53], v33 offset:0
    ds_read_b64_tr_b16 a[54:55], v33 offset:2048
    v_mfma_f32_32x32x16_bf16 v[124:139], a[56:59], v[112:115], v[124:139]
    ds_read_b64_tr_b16 a[56:57], v33 offset:4096
    ds_read_b64_tr_b16 a[58:59], v33 offset:6144
    s_waitcnt lgkmcnt(4)
    v_mfma_f32_32x32x16_bf16 v[124:139], a[60:63], v[116:119], v[124:139]
    ds_read_b64_tr_b16 a[60:61], v33 offset:8192
    ds_read_b64_tr_b16 a[62:63], v33 offset:10240
    v_mfma_f32_32x32x16_bf16 v[124:139], a[64:67], v[120:123], v[124:139]
    ds_read_b64_tr_b16 a[64:65], v33 offset:12288
    ds_read_b64_tr_b16 a[66:67], v33 offset:14336
    s_waitcnt lgkmcnt(4)
    v_mfma_f32_32x32x16_bf16 v[140:155], a[52:55], v[108:111], v[140:155]
    ds_read_b64_tr_b16 a[52:53], v34 offset:0
    ds_read_b64_tr_b16 a[54:55], v34 offset:2048
    v_mfma_f32_32x32x16_bf16 v[140:155], a[56:59], v[112:115], v[140:155]
    s_nop 4
    v_mul_f32 v124, v124, v42
    v_mul_f32 v125, v125, v42
    v_mul_f32 v126, v126, v42
    v_mul_f32 v127, v127, v42
    v_mul_f32 v128, v128, v42
    v_mul_f32 v129, v129, v42
    v_mul_f32 v130, v130, v42
    ds_read_b64_tr_b16 a[56:57], v34 offset:4096
    ds_read_b64_tr_b16 a[58:59], v34 offset:6144
    s_waitcnt lgkmcnt(4)
    v_mfma_f32_32x32x16_bf16 v[140:155], a[60:63], v[116:119], v[140:155]
    v_mul_f32 v131, v131, v42
    v_cvt_pk_bf16_f32 v76, v124, v125
    v_cvt_pk_bf16_f32 v77, v126, v127
    v_cvt_pk_bf16_f32 v78, v128, v129
    v_cvt_pk_bf16_f32 v79, v130, v131
    buffer_store_dwordx4 v[76:79], v4, s[48:51], s65 offen offset:0
    ds_read_b64_tr_b16 a[60:61], v34 offset:8192
    ds_read_b64_tr_b16 a[62:63], v34 offset:10240
    v_mfma_f32_32x32x16_bf16 v[140:155], a[64:67], v[120:123], v[140:155]
    v_mul_f32 v132, v132, v42
    v_mul_f32 v133, v133, v42
    v_mul_f32 v134, v134, v42
    v_mul_f32 v135, v135, v42
    v_mul_f32 v136, v136, v42
    v_mul_f32 v137, v137, v42
    v_mul_f32 v138, v138, v42
    ds_read_b64_tr_b16 a[64:65], v34 offset:12288
    ds_read_b64_tr_b16 a[66:67], v34 offset:14336
    s_waitcnt lgkmcnt(4)
    v_mfma_f32_32x32x16_bf16 v[156:171], a[52:55], v[108:111], v[156:171]
    v_mul_f32 v139, v139, v42
    v_cvt_pk_bf16_f32 v80, v132, v133
    v_cvt_pk_bf16_f32 v81, v134, v135
    v_cvt_pk_bf16_f32 v82, v136, v137
    v_cvt_pk_bf16_f32 v83, v138, v139
    buffer_store_dwordx4 v[80:83], v4, s[48:51], s65 offen offset:1024
    ds_read_b64_tr_b16 a[52:53], v35 offset:0
    ds_read_b64_tr_b16 a[54:55], v35 offset:2048
    v_mfma_f32_32x32x16_bf16 v[156:171], a[56:59], v[112:115], v[156:171]
    v_mul_f32 v140, v140, v42
    v_mul_f32 v141, v141, v42
    v_mul_f32 v142, v142, v42
    v_mul_f32 v143, v143, v42
    v_mul_f32 v144, v144, v42
    v_mul_f32 v145, v145, v42
    v_mul_f32 v146, v146, v42
    ds_read_b64_tr_b16 a[56:57], v35 offset:4096
    ds_read_b64_tr_b16 a[58:59], v35 offset:6144
    s_waitcnt lgkmcnt(4)
    v_mfma_f32_32x32x16_bf16 v[156:171], a[60:63], v[116:119], v[156:171]
    v_mul_f32 v147, v147, v42
    v_cvt_pk_bf16_f32 v84, v140, v141
    v_cvt_pk_bf16_f32 v85, v142, v143
    v_cvt_pk_bf16_f32 v86, v144, v145
    v_cvt_pk_bf16_f32 v87, v146, v147
    buffer_store_dwordx4 v[84:87], v4, s[48:51], s65 offen offset:2048
    ds_read_b64_tr_b16 a[60:61], v35 offset:8192
    ds_read_b64_tr_b16 a[62:63], v35 offset:10240
    v_mfma_f32_32x32x16_bf16 v[156:171], a[64:67], v[120:123], v[156:171]
    v_mul_f32 v148, v148, v42
    v_mul_f32 v149, v149, v42
    v_mul_f32 v150, v150, v42
    v_mul_f32 v151, v151, v42
    v_mul_f32 v152, v152, v42
    v_mul_f32 v153, v153, v42
    v_mul_f32 v154, v154, v42
    ds_read_b64_tr_b16 a[64:65], v35 offset:12288
    ds_read_b64_tr_b16 a[66:67], v35 offset:14336
    s_waitcnt lgkmcnt(4)
    v_mfma_f32_32x32x16_bf16 v[172:187], a[52:55], v[108:111], v[172:187]
    v_mul_f32 v155, v155, v42
    v_cvt_pk_bf16_f32 v88, v148, v149
    v_cvt_pk_bf16_f32 v89, v150, v151
    v_cvt_pk_bf16_f32 v90, v152, v153
    v_cvt_pk_bf16_f32 v91, v154, v155
    buffer_store_dwordx4 v[88:91], v4, s[48:51], s65 offen offset:3072
    v_mfma_f32_32x32x16_bf16 v[172:187], a[56:59], v[112:115], v[172:187]
    v_mul_f32 v156, v156, v42
    v_mul_f32 v157, v157, v42
    v_mul_f32 v158, v158, v42
    v_mul_f32 v159, v159, v42
    v_mul_f32 v160, v160, v42
    v_mul_f32 v161, v161, v42
    v_mul_f32 v162, v162, v42
    v_mul_f32 v163, v163, v42
    v_cvt_pk_bf16_f32 v92, v156, v157
    v_cvt_pk_bf16_f32 v93, v158, v159
    v_cvt_pk_bf16_f32 v94, v160, v161
    v_cvt_pk_bf16_f32 v95, v162, v163
    buffer_store_dwordx4 v[92:95], v4, s[48:51], s66 offen offset:0
    s_waitcnt lgkmcnt(0)
    v_mfma_f32_32x32x16_bf16 v[172:187], a[60:63], v[116:119], v[172:187]
    v_mul_f32 v164, v164, v42
    v_mul_f32 v165, v165, v42
    v_mul_f32 v166, v166, v42
    v_mul_f32 v167, v167, v42
    v_mul_f32 v168, v168, v42
    v_mul_f32 v169, v169, v42
    v_mul_f32 v170, v170, v42
    v_mul_f32 v171, v171, v42
    v_cvt_pk_bf16_f32 v96, v164, v165
    v_cvt_pk_bf16_f32 v97, v166, v167
    v_cvt_pk_bf16_f32 v98, v168, v169
    v_cvt_pk_bf16_f32 v99, v170, v171
    buffer_store_dwordx4 v[96:99], v4, s[48:51], s66 offen offset:1024
    v_mfma_f32_32x32x16_bf16 v[172:187], a[64:67], v[120:123], v[172:187]
    v_lshrrev_b32 v0, 5, v1
    v_mul_u32_u24 v0, 1152, v0
    v_and_b32 v41, 1, v1
    v_lshlrev_b32 v41, 3, v41
    v_add_u32 v0, v0, v41
    v_bfe_u32 v41, v1, 1, 1
    v_lshlrev_b32 v41, 4, v41
    v_add_u32 v0, v0, v41
    v_bfe_u32 v41, v1, 2, 2
    v_lshlrev_b32 v3, 5, v41
    v_add_u32 v36, v0, v3
    v_add_u32 v36, 1024, v36
    v_lshlrev_b32 v3, 8, v41
    v_add_u32 v0, v0, v3
    v_bfe_u32 v3, v1, 4, 1
    v_lshlrev_b32 v3, 5, v3
    v_add_u32 v0, v0, v3
    v_xor_b32 v3, 0, v41
    v_lshlrev_b32 v3, 6, v3
    v_add_u32 v32, v0, v3
    v_xor_b32 v3, 1, v41
    v_lshlrev_b32 v3, 6, v3
    v_add_u32 v33, v0, v3
    v_xor_b32 v3, 2, v41
    v_lshlrev_b32 v3, 6, v3
    v_add_u32 v34, v0, v3
    v_xor_b32 v3, 3, v41
    v_lshlrev_b32 v3, 6, v3
    v_add_u32 v35, v0, v3
    v_pk_mul_f32 v[172:173], v[172:173], v[42:43]
    v_pk_mul_f32 v[174:175], v[174:175], v[42:43]
    v_pk_mul_f32 v[176:177], v[176:177], v[42:43]
    v_pk_mul_f32 v[178:179], v[178:179], v[42:43]
    v_pk_mul_f32 v[180:181], v[180:181], v[42:43]
    v_pk_mul_f32 v[182:183], v[182:183], v[42:43]
    v_pk_mul_f32 v[184:185], v[184:185], v[42:43]
    v_pk_mul_f32 v[186:187], v[186:187], v[42:43]
    v_cvt_pk_bf16_f32 v100, v172, v173
    v_cvt_pk_bf16_f32 v101, v174, v175
    v_cvt_pk_bf16_f32 v102, v176, v177
    v_cvt_pk_bf16_f32 v103, v178, v179
    buffer_store_dwordx4 v[100:103], v4, s[48:51], s66 offen offset:2048
    v_cvt_pk_bf16_f32 v104, v180, v181
    v_cvt_pk_bf16_f32 v105, v182, v183
    v_cvt_pk_bf16_f32 v106, v184, v185
    v_cvt_pk_bf16_f32 v107, v186, v187
    buffer_store_dwordx4 v[104:107], v4, s[48:51], s66 offen offset:3072
    ds_read_b64_tr_b16 v[172:173], v32 offset:0
    ds_read_b64_tr_b16 v[174:175], v32 offset:2304
    ds_read_b64_tr_b16 v[176:177], v33 offset:0
    ds_read_b64_tr_b16 v[178:179], v33 offset:2304
    ds_read_b64_tr_b16 v[180:181], v34 offset:0
    ds_read_b64_tr_b16 v[182:183], v34 offset:2304
    ds_read_b64_tr_b16 v[184:185], v35 offset:0
    ds_read_b64_tr_b16 v[186:187], v35 offset:2304
    s_waitcnt lgkmcnt(4)
    v_mfma_f32_32x32x16_bf16 v[44:59], v[172:175], v[76:79], 0
    v_bfe_u32 v24, v1, 4, 1
    v_mul_u32_u24 v24, 36864, v24
    ds_read_b64_tr_b16 v[172:173], v36 offset:0
    ds_read_b64_tr_b16 v[174:175], v36 offset:2304
    v_mfma_f32_32x32x16_bf16 v[60:75], v[176:179], v[76:79], 0
    v_lshrrev_b32 v25, 5, v1
    v_lshlrev_b32 v25, 8, v25
    ds_read_b64_tr_b16 v[176:177], v32 offset:4608
    ds_read_b64_tr_b16 v[178:179], v32 offset:6912
    s_waitcnt lgkmcnt(4)
    v_mfma_f32_32x32x16_bf16 v[108:123], v[180:183], v[76:79], 0
    v_add_u32 v24, v24, v25
    ds_read_b64_tr_b16 v[180:181], v33 offset:4608
    ds_read_b64_tr_b16 v[182:183], v33 offset:6912
    v_mfma_f32_32x32x16_bf16 v[124:139], v[184:187], v[76:79], 0
    v_and_b32 v25, 15, v1
    v_lshlrev_b32 v26, 4, v25
    ds_read_b64_tr_b16 v[184:185], v34 offset:4608
    ds_read_b64_tr_b16 v[186:187], v34 offset:6912
    s_waitcnt lgkmcnt(4)
    v_mfma_f32_32x32x16_bf16 v[8:23], v[172:175], v[76:79], 0
    v_add_u32 v24, v24, v26
    ds_read_b64_tr_b16 v[172:173], v35 offset:4608
    ds_read_b64_tr_b16 v[174:175], v35 offset:6912
    v_mfma_f32_32x32x16_bf16 v[44:59], v[176:179], v[80:83], v[44:59]
    v_mul_u32_u24 v25, 1152, v25
    v_bfe_u32 v42, v1, 4, 1
    ds_read_b64_tr_b16 v[176:177], v36 offset:4608
    ds_read_b64_tr_b16 v[178:179], v36 offset:6912
    s_waitcnt lgkmcnt(4)
    v_mfma_f32_32x32x16_bf16 v[60:75], v[180:183], v[80:83], v[60:75]
    v_lshlrev_b32 v42, 3, v42
    v_add_u32 v25, v25, v42
    ds_read_b64_tr_b16 v[180:181], v32 offset:9216
    ds_read_b64_tr_b16 v[182:183], v32 offset:11520
    v_mfma_f32_32x32x16_bf16 v[108:123], v[184:187], v[80:83], v[108:123]
    v_lshrrev_b32 v42, 5, v1
    ds_read_b64_tr_b16 v[184:185], v33 offset:9216
    ds_read_b64_tr_b16 v[186:187], v33 offset:11520
    s_waitcnt lgkmcnt(4)
    v_mfma_f32_32x32x16_bf16 v[124:139], v[172:175], v[80:83], v[124:139]
    v_lshlrev_b32 v0, 5, v42
    v_add_u32 v25, v25, v0
    ds_read_b64_tr_b16 v[172:173], v34 offset:9216
    ds_read_b64_tr_b16 v[174:175], v34 offset:11520
    v_mfma_f32_32x32x16_bf16 v[8:23], v[176:179], v[80:83], v[8:23]
    v_lshrrev_b32 v27, 3, v1
    ds_read_b64_tr_b16 v[176:177], v35 offset:9216
    ds_read_b64_tr_b16 v[178:179], v35 offset:11520
    s_waitcnt lgkmcnt(4)
    v_mfma_f32_32x32x16_bf16 v[44:59], v[180:183], v[84:87], v[44:59]
    v_mul_u32_u24 v27, 4608, v27
    v_bfe_u32 v42, v1, 2, 1
    ds_read_b64_tr_b16 v[180:181], v36 offset:9216
    ds_read_b64_tr_b16 v[182:183], v36 offset:11520
    v_mfma_f32_32x32x16_bf16 v[60:75], v[184:187], v[84:87], v[60:75]
    v_lshlrev_b32 v0, 8, v42
    v_add_u32 v27, v27, v0
    ds_read_b64_tr_b16 v[184:185], v32 offset:13824
    ds_read_b64_tr_b16 v[186:187], v32 offset:16128
    s_waitcnt lgkmcnt(4)
    v_mfma_f32_32x32x16_bf16 v[108:123], v[172:175], v[84:87], v[108:123]
    v_lshlrev_b32 v26, 3, v42
    ds_read_b64_tr_b16 v[172:173], v33 offset:13824
    ds_read_b64_tr_b16 v[174:175], v33 offset:16128
    v_mfma_f32_32x32x16_bf16 v[124:139], v[176:179], v[84:87], v[124:139]
    v_add_u32 v26, 256, v26
    v_and_b32 v42, 3, v1
    ds_read_b64_tr_b16 v[176:177], v34 offset:13824
    ds_read_b64_tr_b16 v[178:179], v34 offset:16128
    s_waitcnt lgkmcnt(4)
    v_mfma_f32_32x32x16_bf16 v[8:23], v[180:183], v[84:87], v[8:23]
    s_lshl_b32 s72, s20, 2
    ds_read_b64_tr_b16 v[180:181], v35 offset:13824
    ds_read_b64_tr_b16 v[182:183], v35 offset:16128
    v_mfma_f32_32x32x16_bf16 v[44:59], v[184:187], v[88:91], v[44:59]
    v_add_u32 v42, s72, v42
    v_lshlrev_b32 v0, 4, v42
    ds_read_b64_tr_b16 v[184:185], v36 offset:13824
    ds_read_b64_tr_b16 v[186:187], v36 offset:16128
    s_waitcnt lgkmcnt(4)
    v_mfma_f32_32x32x16_bf16 v[60:75], v[172:175], v[88:91], v[60:75]
    v_add_u32 v27, v27, v0
    s_waitcnt vmcnt(0)
    s_mov_b64 exec, 1
    global_store_dword v6, v7, s[18:19]
    s_mov_b64 exec, -1
    global_load_dword v30, v5, s[18:19] sc1
    global_load_dword v31, v5, s[18:19] sc1
    global_load_dword v41, v5, s[18:19] sc1
    ds_read_b64_tr_b16 v[172:173], v32 offset:18432
    ds_read_b64_tr_b16 v[174:175], v32 offset:20736
    v_mfma_f32_32x32x16_bf16 v[108:123], v[176:179], v[88:91], v[108:123]
    v_mul_u32_u24 v42, 1152, v42
    v_add_u32 v26, v26, v42
    ds_read_b64_tr_b16 v[176:177], v33 offset:18432
    ds_read_b64_tr_b16 v[178:179], v33 offset:20736
    s_waitcnt lgkmcnt(4)
    v_mfma_f32_32x32x16_bf16 v[124:139], v[180:183], v[88:91], v[124:139]
    v_cmp_gt_u32 vcc, 8, v1
    v_mov_b32 v42, 2146435072
    ds_read_b64_tr_b16 v[180:181], v34 offset:18432
    ds_read_b64_tr_b16 v[182:183], v34 offset:20736
    v_mfma_f32_32x32x16_bf16 v[8:23], v[184:187], v[88:91], v[8:23]
    v_cndmask_b32 v26, v42, v26, vcc
    ds_read_b64_tr_b16 v[184:185], v35 offset:18432
    ds_read_b64_tr_b16 v[186:187], v35 offset:20736
    s_waitcnt lgkmcnt(4)
    v_mfma_f32_32x32x16_bf16 v[44:59], v[172:175], v[92:95], v[44:59]
    s_lshl_b32 s72, s23, 2
    s_add_u32 s72, s72, s22
    ds_read_b64_tr_b16 v[172:173], v36 offset:18432
    ds_read_b64_tr_b16 v[174:175], v36 offset:20736
    v_mfma_f32_32x32x16_bf16 v[60:75], v[176:179], v[92:95], v[60:75]
    s_lshl_b32 s72, s72, 9
    ds_read_b64_tr_b16 v[176:177], v32 offset:23040
    ds_read_b64_tr_b16 v[178:179], v32 offset:25344
    s_waitcnt lgkmcnt(4)
    v_mfma_f32_32x32x16_bf16 v[108:123], v[180:183], v[92:95], v[108:123]
    s_add_u32 s72, s72, 33619968
    s_lshl_b32 s73, s20, 7
    ds_read_b64_tr_b16 v[180:181], v33 offset:23040
    ds_read_b64_tr_b16 v[182:183], v33 offset:25344
    v_mfma_f32_32x32x16_bf16 v[124:139], v[184:187], v[92:95], v[124:139]
    s_add_u32 s73, s73, s72
    v_mov_b32 v28, s73
    ds_read_b64_tr_b16 v[184:185], v34 offset:23040
    ds_read_b64_tr_b16 v[186:187], v34 offset:25344
    s_waitcnt lgkmcnt(4)
    v_mfma_f32_32x32x16_bf16 v[8:23], v[172:175], v[92:95], v[8:23]
    s_lshl_b32 s73, s21, 2
    ds_read_b64_tr_b16 v[172:173], v35 offset:23040
    ds_read_b64_tr_b16 v[174:175], v35 offset:25344
    v_mfma_f32_32x32x16_bf16 v[44:59], v[176:179], v[96:99], v[44:59]
    v_add_u32 v28, s73, v28
    s_lshl_b32 s73, s21, 6
    ds_read_b64_tr_b16 v[176:177], v36 offset:23040
    ds_read_b64_tr_b16 v[178:179], v36 offset:25344
    s_waitcnt lgkmcnt(4)
    v_mfma_f32_32x32x16_bf16 v[60:75], v[180:183], v[96:99], v[60:75]
    s_add_u32 s73, s73, s72
    ds_read_b64_tr_b16 v[180:181], v32 offset:27648
    ds_read_b64_tr_b16 v[182:183], v32 offset:29952
    v_mfma_f32_32x32x16_bf16 v[108:123], v[184:187], v[96:99], v[108:123]
    v_and_b32 v29, 7, v1
    v_lshlrev_b32 v29, 2, v29
    ds_read_b64_tr_b16 v[184:185], v33 offset:27648
    ds_read_b64_tr_b16 v[186:187], v33 offset:29952
    s_waitcnt lgkmcnt(4)
    v_mfma_f32_32x32x16_bf16 v[124:139], v[172:175], v[96:99], v[124:139]
    v_add_u32 v29, s73, v29
    ds_read_b64_tr_b16 v[172:173], v34 offset:27648
    ds_read_b64_tr_b16 v[174:175], v34 offset:29952
    v_mfma_f32_32x32x16_bf16 v[8:23], v[176:179], v[96:99], v[8:23]
    ds_read_b64_tr_b16 v[176:177], v35 offset:27648
    ds_read_b64_tr_b16 v[178:179], v35 offset:29952
    s_waitcnt lgkmcnt(4)
    v_mfma_f32_32x32x16_bf16 v[44:59], v[180:183], v[100:103], v[44:59]
    s_waitcnt vmcnt(2)
    v_cmp_ne_u32 vcc, s70, v30
    s_nop 3
    s_cbranch_vccz L_f1backa
    s_mov_b32 s76, 0
    global_load_dword v30, v5, s[18:19] sc1
L_f1loopa:
    s_waitcnt vmcnt(2)
    v_cmp_ne_u32 vcc, s70, v31
    s_nop 4
    s_cbranch_vccz L_f1backa
    s_nop 0
    global_load_dword v31, v5, s[18:19] sc1
    s_waitcnt vmcnt(2)
    v_cmp_ne_u32 vcc, s70, v41
    s_nop 4
    s_cbranch_vccz L_f1backa
    s_nop 0
    global_load_dword v41, v5, s[18:19] sc1
    s_waitcnt vmcnt(2)
    v_cmp_ne_u32 vcc, s70, v30
    s_nop 4
    s_cbranch_vccz L_f1backa
    s_nop 0
    global_load_dword v30, v5, s[18:19] sc1
    s_add_u32 s76, s76, 1
    s_cmp_lt_u32 s76, 65536
    s_cbranch_scc1 L_f1loopa
L_f1backa:
    s_add_u32 s68, s22, 1
    s_and_b32 s68, s68, 3
    s_lshl_b32 s68, s68, 13
    s_add_u32 s67, s68, 4096
    buffer_load_dwordx4 a[0:3], v4, s[48:51], s68 offen offset:0 sc1
    buffer_load_dwordx4 a[4:7], v4, s[48:51], s68 offen offset:1024 sc1
    ds_read_b64_tr_b16 v[180:181], v36 offset:27648
    ds_read_b64_tr_b16 v[182:183], v36 offset:29952
    v_mfma_f32_32x32x16_bf16 v[60:75], v[184:187], v[100:103], v[60:75]
    buffer_load_dwordx4 a[8:11], v4, s[48:51], s68 offen offset:2048 sc1
    buffer_load_dwordx4 a[12:15], v4, s[48:51], s68 offen offset:3072 sc1
    ds_read_b64_tr_b16 v[184:185], v32 offset:32256
    ds_read_b64_tr_b16 v[186:187], v32 offset:34560
    s_waitcnt lgkmcnt(4)
    v_mfma_f32_32x32x16_bf16 v[108:123], v[172:175], v[100:103], v[108:123]
    buffer_load_dwordx4 a[16:19], v4, s[48:51], s67 offen offset:0 sc1
    buffer_load_dwordx4 a[20:23], v4, s[48:51], s67 offen offset:1024 sc1
    ds_read_b64_tr_b16 v[172:173], v33 offset:32256
    ds_read_b64_tr_b16 v[174:175], v33 offset:34560
    v_mfma_f32_32x32x16_bf16 v[124:139], v[176:179], v[100:103], v[124:139]
    buffer_load_dwordx4 a[24:27], v4, s[48:51], s67 offen offset:2048 sc1
    buffer_load_dwordx4 a[28:31], v4, s[48:51], s67 offen offset:3072 sc1
    ds_read_b64_tr_b16 v[176:177], v34 offset:32256
    ds_read_b64_tr_b16 v[178:179], v34 offset:34560
    s_waitcnt lgkmcnt(4)
    v_mfma_f32_32x32x16_bf16 v[8:23], v[180:183], v[100:103], v[8:23]
    s_add_u32 s68, s22, 2
    s_and_b32 s68, s68, 3
    s_lshl_b32 s68, s68, 13
    s_add_u32 s67, s68, 4096
    buffer_load_dwordx4 a[32:35], v4, s[48:51], s68 offen offset:0 sc1
    ds_read_b64_tr_b16 v[180:181], v35 offset:32256
    ds_read_b64_tr_b16 v[182:183], v35 offset:34560
    v_mfma_f32_32x32x16_bf16 v[44:59], v[184:187], v[104:107], v[44:59]
    buffer_load_dwordx4 a[36:39], v4, s[48:51], s68 offen offset:1024 sc1
    buffer_load_dwordx4 a[40:43], v4, s[48:51], s68 offen offset:2048 sc1
    ds_read_b64_tr_b16 v[184:185], v36 offset:32256
    ds_read_b64_tr_b16 v[186:187], v36 offset:34560
    s_waitcnt lgkmcnt(4)
    v_mfma_f32_32x32x16_bf16 v[60:75], v[172:175], v[104:107], v[60:75]
    buffer_load_dwordx4 a[44:47], v4, s[48:51], s68 offen offset:3072 sc1
    buffer_load_dwordx4 a[48:51], v4, s[48:51], s67 offen offset:0 sc1
    v_mfma_f32_32x32x16_bf16 v[108:123], v[176:179], v[104:107], v[108:123]
    buffer_load_dwordx4 a[52:55], v4, s[48:51], s67 offen offset:1024 sc1
    buffer_load_dwordx4 a[56:59], v4, s[48:51], s67 offen offset:2048 sc1
    s_waitcnt lgkmcnt(0)
    v_mfma_f32_32x32x16_bf16 v[124:139], v[180:183], v[104:107], v[124:139]
    buffer_load_dwordx4 a[60:63], v4, s[48:51], s67 offen offset:3072 sc1
    v_mfma_f32_32x32x16_bf16 v[8:23], v[184:187], v[104:107], v[8:23]
L_own_done:
    s_barrier
    v_add_u32 v32, 36864, v32
    ds_read_b64_tr_b16 v[172:173], v32 offset:0
    ds_read_b64_tr_b16 v[174:175], v32 offset:2304
    v_add_u32 v33, 36864, v33
    ds_read_b64_tr_b16 v[176:177], v33 offset:0
    ds_read_b64_tr_b16 v[178:179], v33 offset:2304
    v_add_u32 v34, 36864, v34
    ds_read_b64_tr_b16 v[180:181], v34 offset:0
    ds_read_b64_tr_b16 v[182:183], v34 offset:2304
    v_add_u32 v35, 36864, v35
    ds_read_b64_tr_b16 v[184:185], v35 offset:0
    ds_read_b64_tr_b16 v[186:187], v35 offset:2304
    s_waitcnt lgkmcnt(4)
    s_waitcnt vmcnt(15)
    v_mfma_f32_32x32x16_bf16 v[44:59], v[172:175], a[0:3], v[44:59]
    s_add_u32 s68, s22, 3
    s_and_b32 s68, s68, 3
    s_lshl_b32 s68, s68, 13
    s_add_u32 s67, s68, 4096
    buffer_load_dwordx4 v[140:143], v4, s[48:51], s68 offen offset:0 sc1
    v_add_u32 v36, 36864, v36
    ds_read_b64_tr_b16 v[172:173], v36 offset:0
    ds_read_b64_tr_b16 v[174:175], v36 offset:2304
    v_mfma_f32_32x32x16_bf16 v[60:75], v[176:179], a[0:3], v[60:75]
    ds_read_b64_tr_b16 v[176:177], v32 offset:4608
    ds_read_b64_tr_b16 v[178:179], v32 offset:6912
    s_waitcnt lgkmcnt(4)
    v_mfma_f32_32x32x16_bf16 v[108:123], v[180:183], a[0:3], v[108:123]
    buffer_load_dwordx4 v[144:147], v4, s[48:51], s68 offen offset:1024 sc1
    ds_read_b64_tr_b16 v[180:181], v33 offset:4608
    ds_read_b64_tr_b16 v[182:183], v33 offset:6912
    v_mfma_f32_32x32x16_bf16 v[124:139], v[184:187], a[0:3], v[124:139]
    ds_read_b64_tr_b16 v[184:185], v34 offset:4608
    ds_read_b64_tr_b16 v[186:187], v34 offset:6912
    s_waitcnt lgkmcnt(4)
    v_mfma_f32_32x32x16_bf16 v[8:23], v[172:175], a[0:3], v[8:23]
    buffer_load_dwordx4 v[148:151], v4, s[48:51], s68 offen offset:2048 sc1
    ds_read_b64_tr_b16 v[172:173], v35 offset:4608
    ds_read_b64_tr_b16 v[174:175], v35 offset:6912
    s_waitcnt vmcnt(17)
    v_mfma_f32_32x32x16_bf16 v[44:59], v[176:179], a[4:7], v[44:59]
    ds_read_b64_tr_b16 v[176:177], v36 offset:4608
    ds_read_b64_tr_b16 v[178:179], v36 offset:6912
    s_waitcnt lgkmcnt(4)
    v_mfma_f32_32x32x16_bf16 v[60:75], v[180:183], a[4:7], v[60:75]
    buffer_load_dwordx4 v[152:155], v4, s[48:51], s68 offen offset:3072 sc1
    ds_read_b64_tr_b16 v[180:181], v32 offset:9216
    ds_read_b64_tr_b16 v[182:183], v32 offset:11520
    v_mfma_f32_32x32x16_bf16 v[108:123], v[184:187], a[4:7], v[108:123]
    ds_read_b64_tr_b16 v[184:185], v33 offset:9216
    ds_read_b64_tr_b16 v[186:187], v33 offset:11520
    s_waitcnt lgkmcnt(4)
    v_mfma_f32_32x32x16_bf16 v[124:139], v[172:175], a[4:7], v[124:139]
    buffer_load_dwordx4 v[156:159], v4, s[48:51], s67 offen offset:0 sc1
    ds_read_b64_tr_b16 v[172:173], v34 offset:9216
    ds_read_b64_tr_b16 v[174:175], v34 offset:11520
    v_mfma_f32_32x32x16_bf16 v[8:23], v[176:179], a[4:7], v[8:23]
    ds_read_b64_tr_b16 v[176:177], v35 offset:9216
    ds_read_b64_tr_b16 v[178:179], v35 offset:11520
    s_waitcnt lgkmcnt(4)
    s_waitcnt vmcnt(18)
    v_mfma_f32_32x32x16_bf16 v[44:59], v[180:183], a[8:11], v[44:59]
    buffer_load_dwordx4 v[160:163], v4, s[48:51], s67 offen offset:1024 sc1
    ds_read_b64_tr_b16 v[180:181], v36 offset:9216
    ds_read_b64_tr_b16 v[182:183], v36 offset:11520
    v_mfma_f32_32x32x16_bf16 v[60:75], v[184:187], a[8:11], v[60:75]
    ds_read_b64_tr_b16 v[184:185], v32 offset:13824
    ds_read_b64_tr_b16 v[186:187], v32 offset:16128
    s_waitcnt lgkmcnt(4)
    v_mfma_f32_32x32x16_bf16 v[108:123], v[172:175], a[8:11], v[108:123]
    buffer_load_dwordx4 v[164:167], v4, s[48:51], s67 offen offset:2048 sc1
    ds_read_b64_tr_b16 v[172:173], v33 offset:13824
    ds_read_b64_tr_b16 v[174:175], v33 offset:16128
    v_mfma_f32_32x32x16_bf16 v[124:139], v[176:179], a[8:11], v[124:139]
    ds_read_b64_tr_b16 v[176:177], v34 offset:13824
    ds_read_b64_tr_b16 v[178:179], v34 offset:16128
    s_waitcnt lgkmcnt(4)
    v_mfma_f32_32x32x16_bf16 v[8:23], v[180:183], a[8:11], v[8:23]
    buffer_load_dwordx4 v[168:171], v4, s[48:51], s67 offen offset:3072 sc1
    ds_read_b64_tr_b16 v[180:181], v35 offset:13824
    ds_read_b64_tr_b16 v[182:183], v35 offset:16128
    s_waitcnt vmcnt(20)
    v_mfma_f32_32x32x16_bf16 v[44:59], v[184:187], a[12:15], v[44:59]
    ds_read_b64_tr_b16 v[184:185], v36 offset:13824
    ds_read_b64_tr_b16 v[186:187], v36 offset:16128
    s_waitcnt lgkmcnt(4)
    v_mfma_f32_32x32x16_bf16 v[60:75], v[172:175], a[12:15], v[60:75]
    ds_read_b64_tr_b16 v[172:173], v32 offset:18432
    ds_read_b64_tr_b16 v[174:175], v32 offset:20736
    v_mfma_f32_32x32x16_bf16 v[108:123], v[176:179], a[12:15], v[108:123]
    ds_read_b64_tr_b16 v[176:177], v33 offset:18432
    ds_read_b64_tr_b16 v[178:179], v33 offset:20736
    s_waitcnt lgkmcnt(4)
    v_mfma_f32_32x32x16_bf16 v[124:139], v[180:183], a[12:15], v[124:139]
    ds_read_b64_tr_b16 v[180:181], v34 offset:18432
    ds_read_b64_tr_b16 v[182:183], v34 offset:20736
    v_mfma_f32_32x32x16_bf16 v[8:23], v[184:187], a[12:15], v[8:23]
    ds_read_b64_tr_b16 v[184:185], v35 offset:18432
    ds_read_b64_tr_b16 v[186:187], v35 offset:20736
    s_waitcnt lgkmcnt(4)
    s_waitcnt vmcnt(19)
    v_mfma_f32_32x32x16_bf16 v[44:59], v[172:175], a[16:19], v[44:59]
    ds_read_b64_tr_b16 v[172:173], v36 offset:18432
    ds_read_b64_tr_b16 v[174:175], v36 offset:20736
    v_mfma_f32_32x32x16_bf16 v[60:75], v[176:179], a[16:19], v[60:75]
    ds_read_b64_tr_b16 v[176:177], v32 offset:23040
    ds_read_b64_tr_b16 v[178:179], v32 offset:25344
    s_waitcnt lgkmcnt(4)
    v_mfma_f32_32x32x16_bf16 v[108:123], v[180:183], a[16:19], v[108:123]
    ds_read_b64_tr_b16 v[180:181], v33 offset:23040
    ds_read_b64_tr_b16 v[182:183], v33 offset:25344
    v_mfma_f32_32x32x16_bf16 v[124:139], v[184:187], a[16:19], v[124:139]
    ds_read_b64_tr_b16 v[184:185], v34 offset:23040
    ds_read_b64_tr_b16 v[186:187], v34 offset:25344
    s_waitcnt lgkmcnt(4)
    v_mfma_f32_32x32x16_bf16 v[8:23], v[172:175], a[16:19], v[8:23]
    ds_read_b64_tr_b16 v[172:173], v35 offset:23040
    ds_read_b64_tr_b16 v[174:175], v35 offset:25344
    s_waitcnt vmcnt(18)
    v_mfma_f32_32x32x16_bf16 v[44:59], v[176:179], a[20:23], v[44:59]
    ds_read_b64_tr_b16 v[176:177], v36 offset:23040
    ds_read_b64_tr_b16 v[178:179], v36 offset:25344
    s_waitcnt lgkmcnt(4)
    v_mfma_f32_32x32x16_bf16 v[60:75], v[180:183], a[20:23], v[60:75]
    ds_read_b64_tr_b16 v[180:181], v32 offset:27648
    ds_read_b64_tr_b16 v[182:183], v32 offset:29952
    v_mfma_f32_32x32x16_bf16 v[108:123], v[184:187], a[20:23], v[108:123]
    ds_read_b64_tr_b16 v[184:185], v33 offset:27648
    ds_read_b64_tr_b16 v[186:187], v33 offset:29952
    s_waitcnt lgkmcnt(4)
    v_mfma_f32_32x32x16_bf16 v[124:139], v[172:175], a[20:23], v[124:139]
    ds_read_b64_tr_b16 v[172:173], v34 offset:27648
    ds_read_b64_tr_b16 v[174:175], v34 offset:29952
    v_mfma_f32_32x32x16_bf16 v[8:23], v[176:179], a[20:23], v[8:23]
    ds_read_b64_tr_b16 v[176:177], v35 offset:27648
    ds_read_b64_tr_b16 v[178:179], v35 offset:29952
    s_waitcnt lgkmcnt(4)
    s_waitcnt vmcnt(17)
    v_mfma_f32_32x32x16_bf16 v[44:59], v[180:183], a[24:27], v[44:59]
    ds_read_b64_tr_b16 v[180:181], v36 offset:27648
    ds_read_b64_tr_b16 v[182:183], v36 offset:29952
    v_mfma_f32_32x32x16_bf16 v[60:75], v[184:187], a[24:27], v[60:75]
    ds_read_b64_tr_b16 v[184:185], v32 offset:32256
    ds_read_b64_tr_b16 v[186:187], v32 offset:34560
    s_waitcnt lgkmcnt(4)
    v_mfma_f32_32x32x16_bf16 v[108:123], v[172:175], a[24:27], v[108:123]
    ds_read_b64_tr_b16 v[172:173], v33 offset:32256
    ds_read_b64_tr_b16 v[174:175], v33 offset:34560
    v_mfma_f32_32x32x16_bf16 v[124:139], v[176:179], a[24:27], v[124:139]
    ds_read_b64_tr_b16 v[176:177], v34 offset:32256
    ds_read_b64_tr_b16 v[178:179], v34 offset:34560
    s_waitcnt lgkmcnt(4)
    v_mfma_f32_32x32x16_bf16 v[8:23], v[180:183], a[24:27], v[8:23]
    ds_read_b64_tr_b16 v[180:181], v35 offset:32256
    ds_read_b64_tr_b16 v[182:183], v35 offset:34560
    s_waitcnt vmcnt(16)
    v_mfma_f32_32x32x16_bf16 v[44:59], v[184:187], a[28:31], v[44:59]
    ds_read_b64_tr_b16 v[184:185], v36 offset:32256
    ds_read_b64_tr_b16 v[186:187], v36 offset:34560
    s_waitcnt lgkmcnt(4)
    v_mfma_f32_32x32x16_bf16 v[60:75], v[172:175], a[28:31], v[60:75]
    v_add_u32 v32, 36864, v32
    ds_read_b64_tr_b16 v[172:173], v32 offset:0
    ds_read_b64_tr_b16 v[174:175], v32 offset:2304
    v_mfma_f32_32x32x16_bf16 v[108:123], v[176:179], a[28:31], v[108:123]
    v_add_u32 v33, 36864, v33
    ds_read_b64_tr_b16 v[176:177], v33 offset:0
    ds_read_b64_tr_b16 v[178:179], v33 offset:2304
    s_waitcnt lgkmcnt(4)
    v_mfma_f32_32x32x16_bf16 v[124:139], v[180:183], a[28:31], v[124:139]
    ds_read_b64_tr_b16 v[180:181], v32 offset:4608
    ds_read_b64_tr_b16 v[182:183], v32 offset:6912
    v_mfma_f32_32x32x16_bf16 v[8:23], v[184:187], a[28:31], v[8:23]
    ds_read_b64_tr_b16 v[184:185], v33 offset:4608
    ds_read_b64_tr_b16 v[186:187], v33 offset:6912
    s_waitcnt lgkmcnt(4)
    s_waitcnt vmcnt(15)
    v_mfma_f32_32x32x16_bf16 v[44:59], v[172:175], a[32:35], v[44:59]
    ds_read_b64_tr_b16 v[172:173], v32 offset:9216
    ds_read_b64_tr_b16 v[174:175], v32 offset:11520
    v_mfma_f32_32x32x16_bf16 v[60:75], v[176:179], a[32:35], v[60:75]
    ds_read_b64_tr_b16 v[176:177], v33 offset:9216
    ds_read_b64_tr_b16 v[178:179], v33 offset:11520
    s_waitcnt lgkmcnt(4)
    s_waitcnt vmcnt(14)
    v_mfma_f32_32x32x16_bf16 v[44:59], v[180:183], a[36:39], v[44:59]
    ds_read_b64_tr_b16 v[180:181], v32 offset:13824
    ds_read_b64_tr_b16 v[182:183], v32 offset:16128
    v_mfma_f32_32x32x16_bf16 v[60:75], v[184:187], a[36:39], v[60:75]
    ds_read_b64_tr_b16 v[184:185], v33 offset:13824
    ds_read_b64_tr_b16 v[186:187], v33 offset:16128
    s_waitcnt lgkmcnt(4)
    s_waitcnt vmcnt(13)
    v_mfma_f32_32x32x16_bf16 v[44:59], v[172:175], a[40:43], v[44:59]
    ds_read_b64_tr_b16 v[172:173], v32 offset:18432
    ds_read_b64_tr_b16 v[174:175], v32 offset:20736
    v_mfma_f32_32x32x16_bf16 v[60:75], v[176:179], a[40:43], v[60:75]
    ds_read_b64_tr_b16 v[176:177], v33 offset:18432
    ds_read_b64_tr_b16 v[178:179], v33 offset:20736
    s_waitcnt lgkmcnt(4)
    s_waitcnt vmcnt(12)
    v_mfma_f32_32x32x16_bf16 v[44:59], v[180:183], a[44:47], v[44:59]
    ds_read_b64_tr_b16 v[180:181], v32 offset:23040
    ds_read_b64_tr_b16 v[182:183], v32 offset:25344
    v_mfma_f32_32x32x16_bf16 v[60:75], v[184:187], a[44:47], v[60:75]
    ds_read_b64_tr_b16 v[184:185], v33 offset:23040
    ds_read_b64_tr_b16 v[186:187], v33 offset:25344
    s_waitcnt lgkmcnt(4)
    s_waitcnt vmcnt(11)
    v_mfma_f32_32x32x16_bf16 v[44:59], v[172:175], a[48:51], v[44:59]
    ds_read_b64_tr_b16 v[172:173], v32 offset:27648
    ds_read_b64_tr_b16 v[174:175], v32 offset:29952
    v_mfma_f32_32x32x16_bf16 v[60:75], v[176:179], a[48:51], v[60:75]
    ds_read_b64_tr_b16 v[176:177], v33 offset:27648
    ds_read_b64_tr_b16 v[178:179], v33 offset:29952
    s_waitcnt lgkmcnt(4)
    s_waitcnt vmcnt(10)
    v_mfma_f32_32x32x16_bf16 v[44:59], v[180:183], a[52:55], v[44:59]
    ds_read_b64_tr_b16 v[180:181], v32 offset:32256
    ds_read_b64_tr_b16 v[182:183], v32 offset:34560
    v_mfma_f32_32x32x16_bf16 v[60:75], v[184:187], a[52:55], v[60:75]
    ds_read_b64_tr_b16 v[184:185], v33 offset:32256
    ds_read_b64_tr_b16 v[186:187], v33 offset:34560
    s_waitcnt lgkmcnt(4)
    s_waitcnt vmcnt(9)
    v_mfma_f32_32x32x16_bf16 v[44:59], v[172:175], a[56:59], v[44:59]
    v_add_u32 v32, 36864, v32
    ds_read_b64_tr_b16 v[172:173], v32 offset:0
    ds_read_b64_tr_b16 v[174:175], v32 offset:2304
    v_mfma_f32_32x32x16_bf16 v[60:75], v[176:179], a[56:59], v[60:75]
    v_add_u32 v33, 36864, v33
    ds_read_b64_tr_b16 v[176:177], v33 offset:0
    ds_read_b64_tr_b16 v[178:179], v33 offset:2304
    s_waitcnt lgkmcnt(4)
    s_waitcnt vmcnt(8)
    v_mfma_f32_32x32x16_bf16 v[44:59], v[180:183], a[60:63], v[44:59]
    ds_read_b64_tr_b16 v[180:181], v32 offset:4608
    ds_read_b64_tr_b16 v[182:183], v32 offset:6912
    v_mfma_f32_32x32x16_bf16 v[60:75], v[184:187], a[60:63], v[60:75]
    ds_read_b64_tr_b16 v[184:185], v33 offset:4608
    ds_read_b64_tr_b16 v[186:187], v33 offset:6912
    s_waitcnt lgkmcnt(4)
    s_waitcnt vmcnt(7)
    v_mfma_f32_32x32x16_bf16 v[44:59], v[172:175], v[140:143], v[44:59]
    ds_read_b64_tr_b16 v[172:173], v32 offset:9216
    ds_read_b64_tr_b16 v[174:175], v32 offset:11520
    v_mfma_f32_32x32x16_bf16 v[60:75], v[176:179], v[140:143], v[60:75]
    ds_read_b64_tr_b16 v[176:177], v33 offset:9216
    ds_read_b64_tr_b16 v[178:179], v33 offset:11520
    s_waitcnt lgkmcnt(4)
    s_waitcnt vmcnt(6)
    v_mfma_f32_32x32x16_bf16 v[44:59], v[180:183], v[144:147], v[44:59]
    ds_read_b64_tr_b16 v[180:181], v32 offset:13824
    ds_read_b64_tr_b16 v[182:183], v32 offset:16128
    v_mfma_f32_32x32x16_bf16 v[60:75], v[184:187], v[144:147], v[60:75]
    ds_read_b64_tr_b16 v[184:185], v33 offset:13824
    ds_read_b64_tr_b16 v[186:187], v33 offset:16128
    s_waitcnt lgkmcnt(4)
    s_waitcnt vmcnt(5)
    v_mfma_f32_32x32x16_bf16 v[44:59], v[172:175], v[148:151], v[44:59]
    ds_read_b64_tr_b16 v[172:173], v32 offset:18432
    ds_read_b64_tr_b16 v[174:175], v32 offset:20736
    v_mfma_f32_32x32x16_bf16 v[60:75], v[176:179], v[148:151], v[60:75]
    ds_read_b64_tr_b16 v[176:177], v33 offset:18432
    ds_read_b64_tr_b16 v[178:179], v33 offset:20736
    s_waitcnt lgkmcnt(4)
    s_waitcnt vmcnt(4)
    v_mfma_f32_32x32x16_bf16 v[44:59], v[180:183], v[152:155], v[44:59]
    ds_read_b64_tr_b16 v[180:181], v32 offset:23040
    ds_read_b64_tr_b16 v[182:183], v32 offset:25344
    v_mfma_f32_32x32x16_bf16 v[60:75], v[184:187], v[152:155], v[60:75]
    ds_read_b64_tr_b16 v[184:185], v33 offset:23040
    ds_read_b64_tr_b16 v[186:187], v33 offset:25344
    s_waitcnt lgkmcnt(4)
    s_waitcnt vmcnt(3)
    v_mfma_f32_32x32x16_bf16 v[44:59], v[172:175], v[156:159], v[44:59]
    ds_read_b64_tr_b16 v[172:173], v32 offset:27648
    ds_read_b64_tr_b16 v[174:175], v32 offset:29952
    v_mfma_f32_32x32x16_bf16 v[60:75], v[176:179], v[156:159], v[60:75]
    ds_read_b64_tr_b16 v[176:177], v33 offset:27648
    ds_read_b64_tr_b16 v[178:179], v33 offset:29952
    s_waitcnt lgkmcnt(4)
    s_waitcnt vmcnt(2)
    v_mfma_f32_32x32x16_bf16 v[44:59], v[180:183], v[160:163], v[44:59]
    ds_read_b64_tr_b16 v[180:181], v32 offset:32256
    ds_read_b64_tr_b16 v[182:183], v32 offset:34560
    v_mfma_f32_32x32x16_bf16 v[60:75], v[184:187], v[160:163], v[60:75]
    ds_read_b64_tr_b16 v[184:185], v33 offset:32256
    ds_read_b64_tr_b16 v[186:187], v33 offset:34560
    s_waitcnt lgkmcnt(4)
    s_waitcnt vmcnt(1)
    v_mfma_f32_32x32x16_bf16 v[44:59], v[172:175], v[164:167], v[44:59]
    v_add_u32 v34, 36864, v34
    ds_read_b64_tr_b16 v[172:173], v34 offset:0
    ds_read_b64_tr_b16 v[174:175], v34 offset:2304
    v_mfma_f32_32x32x16_bf16 v[60:75], v[176:179], v[164:167], v[60:75]
    v_add_u32 v35, 36864, v35
    ds_read_b64_tr_b16 v[176:177], v35 offset:0
    ds_read_b64_tr_b16 v[178:179], v35 offset:2304
    s_waitcnt lgkmcnt(4)
    s_waitcnt vmcnt(0)
    v_mfma_f32_32x32x16_bf16 v[44:59], v[180:183], v[168:171], v[44:59]
    ds_read_b64_tr_b16 v[180:181], v34 offset:4608
    ds_read_b64_tr_b16 v[182:183], v34 offset:6912
    v_mfma_f32_32x32x16_bf16 v[60:75], v[184:187], v[168:171], v[60:75]
    ds_read_b64_tr_b16 v[184:185], v35 offset:4608
    ds_read_b64_tr_b16 v[186:187], v35 offset:6912
    s_waitcnt lgkmcnt(4)
    v_mfma_f32_32x32x16_bf16 v[108:123], v[172:175], a[32:35], v[108:123]
    ds_read_b64_tr_b16 v[172:173], v34 offset:9216
    ds_read_b64_tr_b16 v[174:175], v34 offset:11520
    v_mfma_f32_32x32x16_bf16 v[124:139], v[176:179], a[32:35], v[124:139]
    ds_read_b64_tr_b16 v[176:177], v35 offset:9216
    ds_read_b64_tr_b16 v[178:179], v35 offset:11520
    s_waitcnt lgkmcnt(4)
    v_mfma_f32_32x32x16_bf16 v[108:123], v[180:183], a[36:39], v[108:123]
    v_cvt_pk_bf16_f32 v76, v44, v45
    ds_read_b64_tr_b16 v[180:181], v34 offset:13824
    ds_read_b64_tr_b16 v[182:183], v34 offset:16128
    v_mfma_f32_32x32x16_bf16 v[124:139], v[184:187], a[36:39], v[124:139]
    v_cvt_pk_bf16_f32 v77, v46, v47
    ds_read_b64_tr_b16 v[184:185], v35 offset:13824
    ds_read_b64_tr_b16 v[186:187], v35 offset:16128
    s_waitcnt lgkmcnt(4)
    v_mfma_f32_32x32x16_bf16 v[108:123], v[172:175], a[40:43], v[108:123]
    v_cvt_pk_bf16_f32 v78, v48, v49
    ds_read_b64_tr_b16 v[172:173], v34 offset:18432
    ds_read_b64_tr_b16 v[174:175], v34 offset:20736
    v_mfma_f32_32x32x16_bf16 v[124:139], v[176:179], a[40:43], v[124:139]
    v_cvt_pk_bf16_f32 v79, v50, v51
    ds_read_b64_tr_b16 v[176:177], v35 offset:18432
    ds_read_b64_tr_b16 v[178:179], v35 offset:20736
    s_waitcnt lgkmcnt(4)
    v_mfma_f32_32x32x16_bf16 v[108:123], v[180:183], a[44:47], v[108:123]
    buffer_store_dwordx4 v[76:79], v24, s[52:55], s62 offen offset:0 sc1
    ds_read_b64_tr_b16 v[180:181], v34 offset:23040
    ds_read_b64_tr_b16 v[182:183], v34 offset:25344
    v_mfma_f32_32x32x16_bf16 v[124:139], v[184:187], a[44:47], v[124:139]
    v_cvt_pk_bf16_f32 v80, v52, v53
    ds_read_b64_tr_b16 v[184:185], v35 offset:23040
    ds_read_b64_tr_b16 v[186:187], v35 offset:25344
    s_waitcnt lgkmcnt(4)
    v_mfma_f32_32x32x16_bf16 v[108:123], v[172:175], a[48:51], v[108:123]
    v_cvt_pk_bf16_f32 v81, v54, v55
    ds_read_b64_tr_b16 v[172:173], v34 offset:27648
    ds_read_b64_tr_b16 v[174:175], v34 offset:29952
    v_mfma_f32_32x32x16_bf16 v[124:139], v[176:179], a[48:51], v[124:139]
    v_cvt_pk_bf16_f32 v82, v56, v57
    ds_read_b64_tr_b16 v[176:177], v35 offset:27648
    ds_read_b64_tr_b16 v[178:179], v35 offset:29952
    s_waitcnt lgkmcnt(4)
    v_mfma_f32_32x32x16_bf16 v[108:123], v[180:183], a[52:55], v[108:123]
    v_cvt_pk_bf16_f32 v83, v58, v59
    ds_read_b64_tr_b16 v[180:181], v34 offset:32256
    ds_read_b64_tr_b16 v[182:183], v34 offset:34560
    v_mfma_f32_32x32x16_bf16 v[124:139], v[184:187], a[52:55], v[124:139]
    buffer_store_dwordx4 v[80:83], v24, s[52:55], s62 offen offset:512 sc1
    ds_read_b64_tr_b16 v[184:185], v35 offset:32256
    ds_read_b64_tr_b16 v[186:187], v35 offset:34560
    s_waitcnt lgkmcnt(4)
    v_mfma_f32_32x32x16_bf16 v[108:123], v[172:175], a[56:59], v[108:123]
    v_cvt_pk_bf16_f32 v84, v60, v61
    v_add_u32 v34, 36864, v34
    ds_read_b64_tr_b16 v[172:173], v34 offset:0
    ds_read_b64_tr_b16 v[174:175], v34 offset:2304
    v_mfma_f32_32x32x16_bf16 v[124:139], v[176:179], a[56:59], v[124:139]
    v_cvt_pk_bf16_f32 v85, v62, v63
    v_add_u32 v35, 36864, v35
    ds_read_b64_tr_b16 v[176:177], v35 offset:0
    ds_read_b64_tr_b16 v[178:179], v35 offset:2304
    s_waitcnt lgkmcnt(4)
    v_mfma_f32_32x32x16_bf16 v[108:123], v[180:183], a[60:63], v[108:123]
    v_cvt_pk_bf16_f32 v86, v64, v65
    ds_read_b64_tr_b16 v[180:181], v34 offset:4608
    ds_read_b64_tr_b16 v[182:183], v34 offset:6912
    v_mfma_f32_32x32x16_bf16 v[124:139], v[184:187], a[60:63], v[124:139]
    v_cvt_pk_bf16_f32 v87, v66, v67
    ds_read_b64_tr_b16 v[184:185], v35 offset:4608
    ds_read_b64_tr_b16 v[186:187], v35 offset:6912
    s_waitcnt lgkmcnt(4)
    v_mfma_f32_32x32x16_bf16 v[108:123], v[172:175], v[140:143], v[108:123]
    buffer_store_dwordx4 v[84:87], v24, s[52:55], s62 offen offset:1024 sc1
    ds_read_b64_tr_b16 v[172:173], v34 offset:9216
    ds_read_b64_tr_b16 v[174:175], v34 offset:11520
    v_mfma_f32_32x32x16_bf16 v[124:139], v[176:179], v[140:143], v[124:139]
    v_cvt_pk_bf16_f32 v88, v68, v69
    ds_read_b64_tr_b16 v[176:177], v35 offset:9216
    ds_read_b64_tr_b16 v[178:179], v35 offset:11520
    s_waitcnt lgkmcnt(4)
    v_mfma_f32_32x32x16_bf16 v[108:123], v[180:183], v[144:147], v[108:123]
    v_cvt_pk_bf16_f32 v89, v70, v71
    ds_read_b64_tr_b16 v[180:181], v34 offset:13824
    ds_read_b64_tr_b16 v[182:183], v34 offset:16128
    v_mfma_f32_32x32x16_bf16 v[124:139], v[184:187], v[144:147], v[124:139]
    v_cvt_pk_bf16_f32 v90, v72, v73
    ds_read_b64_tr_b16 v[184:185], v35 offset:13824
    ds_read_b64_tr_b16 v[186:187], v35 offset:16128
    s_waitcnt lgkmcnt(4)
    v_mfma_f32_32x32x16_bf16 v[108:123], v[172:175], v[148:151], v[108:123]
    v_cvt_pk_bf16_f32 v91, v74, v75
    ds_read_b64_tr_b16 v[172:173], v34 offset:18432
    ds_read_b64_tr_b16 v[174:175], v34 offset:20736
    v_mfma_f32_32x32x16_bf16 v[124:139], v[176:179], v[148:151], v[124:139]
    buffer_store_dwordx4 v[88:91], v24, s[52:55], s62 offen offset:1536 sc1
    ds_read_b64_tr_b16 v[176:177], v35 offset:18432
    ds_read_b64_tr_b16 v[178:179], v35 offset:20736
    s_waitcnt lgkmcnt(4)
    v_mfma_f32_32x32x16_bf16 v[108:123], v[180:183], v[152:155], v[108:123]
    ds_read_b64_tr_b16 v[180:181], v34 offset:23040
    ds_read_b64_tr_b16 v[182:183], v34 offset:25344
    v_mfma_f32_32x32x16_bf16 v[124:139], v[184:187], v[152:155], v[124:139]
    ds_read_b64_tr_b16 v[184:185], v35 offset:23040
    ds_read_b64_tr_b16 v[186:187], v35 offset:25344
    s_waitcnt lgkmcnt(4)
    v_mfma_f32_32x32x16_bf16 v[108:123], v[172:175], v[156:159], v[108:123]
    ds_read_b64_tr_b16 v[172:173], v34 offset:27648
    ds_read_b64_tr_b16 v[174:175], v34 offset:29952
    v_mfma_f32_32x32x16_bf16 v[124:139], v[176:179], v[156:159], v[124:139]
    ds_read_b64_tr_b16 v[176:177], v35 offset:27648
    ds_read_b64_tr_b16 v[178:179], v35 offset:29952
    s_waitcnt lgkmcnt(4)
    v_mfma_f32_32x32x16_bf16 v[108:123], v[180:183], v[160:163], v[108:123]
    ds_read_b64_tr_b16 v[180:181], v34 offset:32256
    ds_read_b64_tr_b16 v[182:183], v34 offset:34560
    v_mfma_f32_32x32x16_bf16 v[124:139], v[184:187], v[160:163], v[124:139]
    ds_read_b64_tr_b16 v[184:185], v35 offset:32256
    ds_read_b64_tr_b16 v[186:187], v35 offset:34560
    s_waitcnt lgkmcnt(4)
    v_mfma_f32_32x32x16_bf16 v[108:123], v[172:175], v[164:167], v[108:123]
    v_add_u32 v36, 36864, v36
    ds_read_b64_tr_b16 v[172:173], v36 offset:0
    ds_read_b64_tr_b16 v[174:175], v36 offset:2304
    v_mfma_f32_32x32x16_bf16 v[124:139], v[176:179], v[164:167], v[124:139]
    ds_read_b64_tr_b16 v[176:177], v36 offset:4608
    ds_read_b64_tr_b16 v[178:179], v36 offset:6912
    s_waitcnt lgkmcnt(4)
    v_mfma_f32_32x32x16_bf16 v[108:123], v[180:183], v[168:171], v[108:123]
    ds_read_b64_tr_b16 v[180:181], v36 offset:9216
    ds_read_b64_tr_b16 v[182:183], v36 offset:11520
    v_mfma_f32_32x32x16_bf16 v[124:139], v[184:187], v[168:171], v[124:139]
    ds_read_b64_tr_b16 v[184:185], v36 offset:13824
    ds_read_b64_tr_b16 v[186:187], v36 offset:16128
    s_waitcnt lgkmcnt(4)
    v_mfma_f32_32x32x16_bf16 v[8:23], v[172:175], a[32:35], v[8:23]
    ds_read_b64_tr_b16 v[172:173], v36 offset:18432
    ds_read_b64_tr_b16 v[174:175], v36 offset:20736
    v_mfma_f32_32x32x16_bf16 v[8:23], v[176:179], a[36:39], v[8:23]
    ds_read_b64_tr_b16 v[176:177], v36 offset:23040
    ds_read_b64_tr_b16 v[178:179], v36 offset:25344
    s_waitcnt lgkmcnt(4)
    v_mfma_f32_32x32x16_bf16 v[8:23], v[180:183], a[40:43], v[8:23]
    v_cvt_pk_bf16_f32 v92, v108, v109
    v_cvt_pk_bf16_f32 v93, v110, v111
    ds_read_b64_tr_b16 v[180:181], v36 offset:27648
    ds_read_b64_tr_b16 v[182:183], v36 offset:29952
    v_mfma_f32_32x32x16_bf16 v[8:23], v[184:187], a[44:47], v[8:23]
    v_cvt_pk_bf16_f32 v94, v112, v113
    v_cvt_pk_bf16_f32 v95, v114, v115
    ds_read_b64_tr_b16 v[184:185], v36 offset:32256
    ds_read_b64_tr_b16 v[186:187], v36 offset:34560
    s_waitcnt lgkmcnt(4)
    v_mfma_f32_32x32x16_bf16 v[8:23], v[172:175], a[48:51], v[8:23]
    buffer_store_dwordx4 v[92:95], v24, s[52:55], s62 offen offset:2048 sc1
    v_add_u32 v36, 36864, v36
    ds_read_b64_tr_b16 v[172:173], v36 offset:0
    ds_read_b64_tr_b16 v[174:175], v36 offset:2304
    v_mfma_f32_32x32x16_bf16 v[8:23], v[176:179], a[52:55], v[8:23]
    v_cvt_pk_bf16_f32 v96, v116, v117
    v_cvt_pk_bf16_f32 v97, v118, v119
    ds_read_b64_tr_b16 v[176:177], v36 offset:4608
    ds_read_b64_tr_b16 v[178:179], v36 offset:6912
    s_waitcnt lgkmcnt(4)
    v_mfma_f32_32x32x16_bf16 v[8:23], v[180:183], a[56:59], v[8:23]
    v_cvt_pk_bf16_f32 v98, v120, v121
    ds_read_b64_tr_b16 v[180:181], v36 offset:9216
    ds_read_b64_tr_b16 v[182:183], v36 offset:11520
    v_mfma_f32_32x32x16_bf16 v[8:23], v[184:187], a[60:63], v[8:23]
    v_cvt_pk_bf16_f32 v99, v122, v123
    buffer_store_dwordx4 v[96:99], v24, s[52:55], s62 offen offset:2560 sc1
    ds_read_b64_tr_b16 v[184:185], v36 offset:13824
    ds_read_b64_tr_b16 v[186:187], v36 offset:16128
    s_waitcnt lgkmcnt(4)
    v_mfma_f32_32x32x16_bf16 v[8:23], v[172:175], v[140:143], v[8:23]
    v_cvt_pk_bf16_f32 v100, v124, v125
    ds_read_b64_tr_b16 v[172:173], v36 offset:18432
    ds_read_b64_tr_b16 v[174:175], v36 offset:20736
    v_mfma_f32_32x32x16_bf16 v[8:23], v[176:179], v[144:147], v[8:23]
    v_cvt_pk_bf16_f32 v101, v126, v127
    v_cvt_pk_bf16_f32 v102, v128, v129
    ds_read_b64_tr_b16 v[176:177], v36 offset:23040
    ds_read_b64_tr_b16 v[178:179], v36 offset:25344
    s_waitcnt lgkmcnt(4)
    v_mfma_f32_32x32x16_bf16 v[8:23], v[180:183], v[148:151], v[8:23]
    v_cvt_pk_bf16_f32 v103, v130, v131
    ds_read_b64_tr_b16 v[180:181], v36 offset:27648
    ds_read_b64_tr_b16 v[182:183], v36 offset:29952
    v_mfma_f32_32x32x16_bf16 v[8:23], v[184:187], v[152:155], v[8:23]
    buffer_store_dwordx4 v[100:103], v24, s[52:55], s62 offen offset:3072 sc1
    v_cvt_pk_bf16_f32 v104, v132, v133
    ds_read_b64_tr_b16 v[184:185], v36 offset:32256
    ds_read_b64_tr_b16 v[186:187], v36 offset:34560
    s_waitcnt lgkmcnt(4)
    v_mfma_f32_32x32x16_bf16 v[8:23], v[172:175], v[156:159], v[8:23]
    v_cvt_pk_bf16_f32 v105, v134, v135
    v_mfma_f32_32x32x16_bf16 v[8:23], v[176:179], v[160:163], v[8:23]
    v_cvt_pk_bf16_f32 v106, v136, v137
    v_cvt_pk_bf16_f32 v107, v138, v139
    s_waitcnt lgkmcnt(0)
    v_mfma_f32_32x32x16_bf16 v[8:23], v[180:183], v[164:167], v[8:23]
    buffer_store_dwordx4 v[104:107], v24, s[52:55], s62 offen offset:3584 sc1
    v_mfma_f32_32x32x16_bf16 v[8:23], v[184:187], v[168:171], v[8:23]
    s_nop 11
    v_cvt_pk_bf16_f32 v44, v8, v9
    v_cvt_pk_bf16_f32 v45, v10, v11
    v_cvt_pk_bf16_f32 v46, v12, v13
    v_cvt_pk_bf16_f32 v47, v14, v15
    buffer_store_dwordx4 v[44:47], v24, s[52:55], s3 offen sc1
    v_mov_b32 v0, s70
    s_mul_i32 s65, s21, 36864
    s_lshl_b32 s66, s20, 10
    s_add_u32 s66, s66, s65
    s_add_u32 s67, s65, 4096
    s_mov_b32 s76, 0
    s_waitcnt vmcnt(0)
    s_mov_b64 exec, 1
    global_store_dword v28, v0, s[18:19] sc1
    global_store_dword v28, v0, s[18:19] offset:64 sc1
    s_mov_b64 exec, -1
    s_mov_b32 s72, 0
L_f2spin:
    global_load_dword v30, v29, s[18:19] sc1
    s_waitcnt vmcnt(0)
    v_cmp_eq_u32 vcc, s70, v30
    s_add_u32 s76, s76, 1
    s_nop 3
    s_and_b32 s73, vcc_lo, 0xff
    s_andn2_b32 s73, s73, s72
    s_cbranch_scc0 L_f2none
    s_bitcmp1_b32 s73, 0
    s_cbranch_scc0 L_f2skip0
    s_add_u32 s68, s66, 0
    buffer_load_dwordx4 v[140:143], v4, s[52:55], s68 offen sc1
L_f2skip0:
    s_bitcmp1_b32 s73, 1
    s_cbranch_scc0 L_f2skip1
    s_add_u32 s68, s66, 4608
    buffer_load_dwordx4 v[144:147], v4, s[52:55], s68 offen sc1
L_f2skip1:
    s_bitcmp1_b32 s73, 2
    s_cbranch_scc0 L_f2skip2
    s_add_u32 s68, s66, 9216
    buffer_load_dwordx4 v[148:151], v4, s[52:55], s68 offen sc1
L_f2skip2:
    s_bitcmp1_b32 s73, 3
    s_cbranch_scc0 L_f2skip3
    s_add_u32 s68, s66, 13824
    buffer_load_dwordx4 v[152:155], v4, s[52:55], s68 offen sc1
L_f2skip3:
    s_bitcmp1_b32 s73, 4
    s_cbranch_scc0 L_f2skip4
    s_add_u32 s68, s66, 18432
    buffer_load_dwordx4 v[156:159], v4, s[52:55], s68 offen sc1
L_f2skip4:
    s_bitcmp1_b32 s73, 5
    s_cbranch_scc0 L_f2skip5
    s_add_u32 s68, s66, 23040
    buffer_load_dwordx4 v[160:163], v4, s[52:55], s68 offen sc1
L_f2skip5:
    s_bitcmp1_b32 s73, 6
    s_cbranch_scc0 L_f2skip6
    s_add_u32 s68, s66, 27648
    buffer_load_dwordx4 v[164:167], v4, s[52:55], s68 offen sc1
L_f2skip6:
    s_bitcmp1_b32 s73, 7
    s_cbranch_scc0 L_f2skip7
    s_add_u32 s68, s66, 32256
    buffer_load_dwordx4 v[168:171], v4, s[52:55], s68 offen sc1
L_f2skip7:
    s_or_b32 s72, s72, s73
    s_cmp_eq_u32 s72, 0xff
    s_cbranch_scc1 L_f2ok
L_f2none:
    s_cmp_lt_u32 s76, 65536
    s_cbranch_scc1 L_f2spin
L_f2ok:
    buffer_load_dwordx4 v[172:175], v27, s[52:55], s67 offen sc1
    s_waitcnt vmcnt(1)
    v_lshlrev_b32 v108, 16, v140
    v_and_b32 v109, 0xffff0000, v140
    v_lshlrev_b32 v110, 16, v141
    v_and_b32 v111, 0xffff0000, v141
    v_lshlrev_b32 v112, 16, v142
    v_and_b32 v113, 0xffff0000, v142
    v_lshlrev_b32 v114, 16, v143
    v_and_b32 v115, 0xffff0000, v143
    v_lshlrev_b32 v42, 16, v144
    v_and_b32 v43, 0xffff0000, v144
    v_pk_add_f32 v[108:109], v[108:109], v[42:43]
    v_lshlrev_b32 v42, 16, v145
    v_and_b32 v43, 0xffff0000, v145
    v_pk_add_f32 v[110:111], v[110:111], v[42:43]
    v_lshlrev_b32 v42, 16, v146
    v_and_b32 v43, 0xffff0000, v146
    v_pk_add_f32 v[112:113], v[112:113], v[42:43]
    v_lshlrev_b32 v42, 16, v147
    v_and_b32 v43, 0xffff0000, v147
    v_pk_add_f32 v[114:115], v[114:115], v[42:43]
    v_lshlrev_b32 v42, 16, v148
    v_and_b32 v43, 0xffff0000, v148
    v_pk_add_f32 v[108:109], v[108:109], v[42:43]
    v_lshlrev_b32 v42, 16, v149
    v_and_b32 v43, 0xffff0000, v149
    v_pk_add_f32 v[110:111], v[110:111], v[42:43]
    v_lshlrev_b32 v42, 16, v150
    v_and_b32 v43, 0xffff0000, v150
    v_pk_add_f32 v[112:113], v[112:113], v[42:43]
    v_lshlrev_b32 v42, 16, v151
    v_and_b32 v43, 0xffff0000, v151
    v_pk_add_f32 v[114:115], v[114:115], v[42:43]
    v_lshlrev_b32 v42, 16, v152
    v_and_b32 v43, 0xffff0000, v152
    v_pk_add_f32 v[108:109], v[108:109], v[42:43]
    v_lshlrev_b32 v42, 16, v153
    v_and_b32 v43, 0xffff0000, v153
    v_pk_add_f32 v[110:111], v[110:111], v[42:43]
    v_lshlrev_b32 v42, 16, v154
    v_and_b32 v43, 0xffff0000, v154
    v_pk_add_f32 v[112:113], v[112:113], v[42:43]
    v_lshlrev_b32 v42, 16, v155
    v_and_b32 v43, 0xffff0000, v155
    v_pk_add_f32 v[114:115], v[114:115], v[42:43]
    v_lshlrev_b32 v42, 16, v156
    v_and_b32 v43, 0xffff0000, v156
    v_pk_add_f32 v[108:109], v[108:109], v[42:43]
    v_lshlrev_b32 v42, 16, v157
    v_and_b32 v43, 0xffff0000, v157
    v_pk_add_f32 v[110:111], v[110:111], v[42:43]
    v_lshlrev_b32 v42, 16, v158
    v_and_b32 v43, 0xffff0000, v158
    v_pk_add_f32 v[112:113], v[112:113], v[42:43]
    v_lshlrev_b32 v42, 16, v159
    v_and_b32 v43, 0xffff0000, v159
    v_pk_add_f32 v[114:115], v[114:115], v[42:43]
    v_lshlrev_b32 v42, 16, v160
    v_and_b32 v43, 0xffff0000, v160
    v_pk_add_f32 v[108:109], v[108:109], v[42:43]
    v_lshlrev_b32 v42, 16, v161
    v_and_b32 v43, 0xffff0000, v161
    v_pk_add_f32 v[110:111], v[110:111], v[42:43]
    v_lshlrev_b32 v42, 16, v162
    v_and_b32 v43, 0xffff0000, v162
    v_pk_add_f32 v[112:113], v[112:113], v[42:43]
    v_lshlrev_b32 v42, 16, v163
    v_and_b32 v43, 0xffff0000, v163
    v_pk_add_f32 v[114:115], v[114:115], v[42:43]
    v_lshlrev_b32 v42, 16, v164
    v_and_b32 v43, 0xffff0000, v164
    v_pk_add_f32 v[108:109], v[108:109], v[42:43]
    v_lshlrev_b32 v42, 16, v165
    v_and_b32 v43, 0xffff0000, v165
    v_pk_add_f32 v[110:111], v[110:111], v[42:43]
    v_lshlrev_b32 v42, 16, v166
    v_and_b32 v43, 0xffff0000, v166
    v_pk_add_f32 v[112:113], v[112:113], v[42:43]
    v_lshlrev_b32 v42, 16, v167
    v_and_b32 v43, 0xffff0000, v167
    v_pk_add_f32 v[114:115], v[114:115], v[42:43]
    v_lshlrev_b32 v42, 16, v168
    v_and_b32 v43, 0xffff0000, v168
    v_pk_add_f32 v[108:109], v[108:109], v[42:43]
    v_lshlrev_b32 v42, 16, v169
    v_and_b32 v43, 0xffff0000, v169
    v_pk_add_f32 v[110:111], v[110:111], v[42:43]
    v_lshlrev_b32 v42, 16, v170
    v_and_b32 v43, 0xffff0000, v170
    v_pk_add_f32 v[112:113], v[112:113], v[42:43]
    v_lshlrev_b32 v42, 16, v171
    v_and_b32 v43, 0xffff0000, v171
    v_pk_add_f32 v[114:115], v[114:115], v[42:43]
    v_cvt_pk_bf16_f32 v116, v108, v109
    v_cvt_pk_bf16_f32 v117, v110, v111
    v_cvt_pk_bf16_f32 v118, v112, v113
    v_cvt_pk_bf16_f32 v119, v114, v115
    s_lshl_b32 s66, s20, 6
    buffer_store_dwordx2 v[116:117], v25, s[56:59], s66 offen
    buffer_store_dwordx2 v[118:119], v25, s[56:59], s66 offen offset:16
    s_waitcnt vmcnt(2)
    v_lshlrev_b32 v124, 16, v172
    v_and_b32 v125, 0xffff0000, v172
    v_lshlrev_b32 v126, 16, v173
    v_and_b32 v127, 0xffff0000, v173
    v_lshlrev_b32 v128, 16, v174
    v_and_b32 v129, 0xffff0000, v174
    v_lshlrev_b32 v130, 16, v175
    v_and_b32 v131, 0xffff0000, v175
    v_add_f32_dpp v124, v124, v124 row_ror:8 row_mask:0xf bank_mask:0xf
    v_add_f32_dpp v125, v125, v125 row_ror:8 row_mask:0xf bank_mask:0xf
    v_add_f32_dpp v126, v126, v126 row_ror:8 row_mask:0xf bank_mask:0xf
    v_add_f32_dpp v127, v127, v127 row_ror:8 row_mask:0xf bank_mask:0xf
    v_add_f32_dpp v128, v128, v128 row_ror:8 row_mask:0xf bank_mask:0xf
    v_add_f32_dpp v129, v129, v129 row_ror:8 row_mask:0xf bank_mask:0xf
    v_add_f32_dpp v130, v130, v130 row_ror:8 row_mask:0xf bank_mask:0xf
    v_add_f32_dpp v131, v131, v131 row_ror:8 row_mask:0xf bank_mask:0xf
    v_mov_b32 v132, v124
    v_mov_b32 v133, v125
    v_mov_b32 v134, v126
    v_mov_b32 v135, v127
    v_mov_b32 v136, v128
    v_mov_b32 v137, v129
    v_mov_b32 v138, v130
    v_mov_b32 v139, v131
    v_permlane16_swap_b32 v124, v132
    v_permlane16_swap_b32 v125, v133
    v_permlane16_swap_b32 v126, v134
    v_permlane16_swap_b32 v127, v135
    v_permlane16_swap_b32 v128, v136
    v_permlane16_swap_b32 v129, v137
    v_permlane16_swap_b32 v130, v138
    v_permlane16_swap_b32 v131, v139
    v_pk_add_f32 v[124:125], v[124:125], v[132:133]
    v_pk_add_f32 v[126:127], v[126:127], v[134:135]
    v_pk_add_f32 v[128:129], v[128:129], v[136:137]
    v_pk_add_f32 v[130:131], v[130:131], v[138:139]
    v_mov_b32 v132, v124
    v_mov_b32 v133, v125
    v_mov_b32 v134, v126
    v_mov_b32 v135, v127
    v_mov_b32 v136, v128
    v_mov_b32 v137, v129
    v_mov_b32 v138, v130
    v_mov_b32 v139, v131
    v_permlane32_swap_b32 v124, v132
    v_permlane32_swap_b32 v125, v133
    v_permlane32_swap_b32 v126, v134
    v_permlane32_swap_b32 v127, v135
    v_permlane32_swap_b32 v128, v136
    v_permlane32_swap_b32 v129, v137
    v_permlane32_swap_b32 v130, v138
    v_permlane32_swap_b32 v131, v139
    v_pk_add_f32 v[124:125], v[124:125], v[132:133]
    v_pk_add_f32 v[126:127], v[126:127], v[134:135]
    v_pk_add_f32 v[128:129], v[128:129], v[136:137]
    v_pk_add_f32 v[130:131], v[130:131], v[138:139]
    v_cvt_pk_bf16_f32 v120, v124, v125
    v_cvt_pk_bf16_f32 v121, v126, v127
    v_cvt_pk_bf16_f32 v122, v128, v129
    v_cvt_pk_bf16_f32 v123, v130, v131
    buffer_store_dwordx2 v[120:121], v26, s[56:59], 0 offen
    buffer_store_dwordx2 v[122:123], v26, s[56:59], 0 offen offset:16
L_done:
    s_endpgm
L_resc_1:
    s_nop 15
    v_mov_b32 v40, v39
    s_nop 1
    v_permlane32_swap_b32 v39, v40
    s_nop 1
    v_max_f32 v39, v39, v40
    v_add_f32 v39, v39, v37
    v_max_f32 v39, v39, v36
    v_sub_f32 v40, v36, v39
    v_exp_f32 v40, v40
    v_sub_f32 v38, v39, v37
    v_accvgpr_read_b32 v37, a36
    v_sub_f32 v44, v44, v38
    v_sub_f32 v45, v45, v38
    v_sub_f32 v46, v46, v38
    v_sub_f32 v47, v47, v38
    v_sub_f32 v48, v48, v38
    v_sub_f32 v49, v49, v38
    v_sub_f32 v50, v50, v38
    v_sub_f32 v51, v51, v38
    v_sub_f32 v52, v52, v38
    v_sub_f32 v53, v53, v38
    v_sub_f32 v54, v54, v38
    v_sub_f32 v55, v55, v38
    v_sub_f32 v56, v56, v38
    v_sub_f32 v57, v57, v38
    v_sub_f32 v58, v58, v38
    v_sub_f32 v59, v59, v38
    v_sub_f32 v60, v60, v38
    v_sub_f32 v61, v61, v38
    v_sub_f32 v62, v62, v38
    v_sub_f32 v63, v63, v38
    v_sub_f32 v64, v64, v38
    v_sub_f32 v65, v65, v38
    v_sub_f32 v66, v66, v38
    v_sub_f32 v67, v67, v38
    v_sub_f32 v68, v68, v38
    v_sub_f32 v69, v69, v38
    v_sub_f32 v70, v70, v38
    v_sub_f32 v71, v71, v38
    v_sub_f32 v72, v72, v38
    v_sub_f32 v73, v73, v38
    v_sub_f32 v74, v74, v38
    v_sub_f32 v75, v75, v38
    v_mul_f32 v37, v40, v37
    v_accvgpr_write_b32 a36, v37
    v_mul_f32 v124, v40, v124
    v_mul_f32 v125, v40, v125
    v_mul_f32 v126, v40, v126
    v_mul_f32 v127, v40, v127
    v_mul_f32 v128, v40, v128
    v_mul_f32 v129, v40, v129
    v_mul_f32 v130, v40, v130
    v_mul_f32 v131, v40, v131
    v_mul_f32 v132, v40, v132
    v_mul_f32 v133, v40, v133
    v_mul_f32 v134, v40, v134
    v_mul_f32 v135, v40, v135
    v_mul_f32 v136, v40, v136
    v_mul_f32 v137, v40, v137
    v_mul_f32 v138, v40, v138
    v_mul_f32 v139, v40, v139
    v_mul_f32 v140, v40, v140
    v_mul_f32 v141, v40, v141
    v_mul_f32 v142, v40, v142
    v_mul_f32 v143, v40, v143
    v_mul_f32 v144, v40, v144
    v_mul_f32 v145, v40, v145
    v_mul_f32 v146, v40, v146
    v_mul_f32 v147, v40, v147
    v_mul_f32 v148, v40, v148
    v_mul_f32 v149, v40, v149
    v_mul_f32 v150, v40, v150
    v_mul_f32 v151, v40, v151
    v_mul_f32 v152, v40, v152
    v_mul_f32 v153, v40, v153
    v_mul_f32 v154, v40, v154
    v_mul_f32 v155, v40, v155
    v_mul_f32 v156, v40, v156
    v_mul_f32 v157, v40, v157
    v_mul_f32 v158, v40, v158
    v_mul_f32 v159, v40, v159
    v_mul_f32 v160, v40, v160
    v_mul_f32 v161, v40, v161
    v_mul_f32 v162, v40, v162
    v_mul_f32 v163, v40, v163
    v_mul_f32 v164, v40, v164
    v_mul_f32 v165, v40, v165
    v_mul_f32 v166, v40, v166
    v_mul_f32 v167, v40, v167
    v_mul_f32 v168, v40, v168
    v_mul_f32 v169, v40, v169
    v_mul_f32 v170, v40, v170
    v_mul_f32 v171, v40, v171
    v_mul_f32 v172, v40, v172
    v_mul_f32 v173, v40, v173
    v_mul_f32 v174, v40, v174
    v_mul_f32 v175, v40, v175
    v_mul_f32 v176, v40, v176
    v_mul_f32 v177, v40, v177
    v_mul_f32 v178, v40, v178
    v_mul_f32 v179, v40, v179
    v_mul_f32 v180, v40, v180
    v_mul_f32 v181, v40, v181
    v_mul_f32 v182, v40, v182
    v_mul_f32 v183, v40, v183
    v_mul_f32 v184, v40, v184
    v_mul_f32 v185, v40, v185
    v_mul_f32 v186, v40, v186
    v_mul_f32 v187, v40, v187
    v_cmp_gt_f32 vcc, v39, v36
    v_mov_b32 v37, v36
    v_mov_b32 v36, v39
    v_mov_b32 v38, 0x41000000
    v_mov_b32 v40, 0xff800000
    v_cndmask_b32 v38, v38, v40, vcc
    v_sub_f32 v8, 0, v36
    v_mov_b32 v9, v8
    v_mov_b32 v10, v8
    v_mov_b32 v11, v8
    v_mov_b32 v12, v8
    v_mov_b32 v13, v8
    v_mov_b32 v14, v8
    v_mov_b32 v15, v8
    v_mov_b32 v16, v8
    v_mov_b32 v17, v8
    v_mov_b32 v18, v8
    v_mov_b32 v19, v8
    v_mov_b32 v20, v8
    v_mov_b32 v21, v8
    v_mov_b32 v22, v8
    v_mov_b32 v23, v8
    s_nop 7
    s_branch L_resc_1_back
L_resc_2:
    s_nop 15
    v_mov_b32 v40, v39
    s_nop 1
    v_permlane32_swap_b32 v39, v40
    s_nop 1
    v_max_f32 v39, v39, v40
    v_add_f32 v39, v39, v37
    v_max_f32 v39, v39, v36
    v_sub_f32 v40, v36, v39
    v_exp_f32 v40, v40
    v_sub_f32 v38, v39, v37
    v_accvgpr_read_b32 v37, a36
    v_sub_f32 v76, v76, v38
    v_sub_f32 v77, v77, v38
    v_sub_f32 v78, v78, v38
    v_sub_f32 v79, v79, v38
    v_sub_f32 v80, v80, v38
    v_sub_f32 v81, v81, v38
    v_sub_f32 v82, v82, v38
    v_sub_f32 v83, v83, v38
    v_sub_f32 v84, v84, v38
    v_sub_f32 v85, v85, v38
    v_sub_f32 v86, v86, v38
    v_sub_f32 v87, v87, v38
    v_sub_f32 v88, v88, v38
    v_sub_f32 v89, v89, v38
    v_sub_f32 v90, v90, v38
    v_sub_f32 v91, v91, v38
    v_sub_f32 v92, v92, v38
    v_sub_f32 v93, v93, v38
    v_sub_f32 v94, v94, v38
    v_sub_f32 v95, v95, v38
    v_sub_f32 v96, v96, v38
    v_sub_f32 v97, v97, v38
    v_sub_f32 v98, v98, v38
    v_sub_f32 v99, v99, v38
    v_sub_f32 v100, v100, v38
    v_sub_f32 v101, v101, v38
    v_sub_f32 v102, v102, v38
    v_sub_f32 v103, v103, v38
    v_sub_f32 v104, v104, v38
    v_sub_f32 v105, v105, v38
    v_sub_f32 v106, v106, v38
    v_sub_f32 v107, v107, v38
    v_mul_f32 v37, v40, v37
    v_accvgpr_write_b32 a36, v37
    v_mul_f32 v124, v40, v124
    v_mul_f32 v125, v40, v125
    v_mul_f32 v126, v40, v126
    v_mul_f32 v127, v40, v127
    v_mul_f32 v128, v40, v128
    v_mul_f32 v129, v40, v129
    v_mul_f32 v130, v40, v130
    v_mul_f32 v131, v40, v131
    v_mul_f32 v132, v40, v132
    v_mul_f32 v133, v40, v133
    v_mul_f32 v134, v40, v134
    v_mul_f32 v135, v40, v135
    v_mul_f32 v136, v40, v136
    v_mul_f32 v137, v40, v137
    v_mul_f32 v138, v40, v138
    v_mul_f32 v139, v40, v139
    v_mul_f32 v140, v40, v140
    v_mul_f32 v141, v40, v141
    v_mul_f32 v142, v40, v142
    v_mul_f32 v143, v40, v143
    v_mul_f32 v144, v40, v144
    v_mul_f32 v145, v40, v145
    v_mul_f32 v146, v40, v146
    v_mul_f32 v147, v40, v147
    v_mul_f32 v148, v40, v148
    v_mul_f32 v149, v40, v149
    v_mul_f32 v150, v40, v150
    v_mul_f32 v151, v40, v151
    v_mul_f32 v152, v40, v152
    v_mul_f32 v153, v40, v153
    v_mul_f32 v154, v40, v154
    v_mul_f32 v155, v40, v155
    v_mul_f32 v156, v40, v156
    v_mul_f32 v157, v40, v157
    v_mul_f32 v158, v40, v158
    v_mul_f32 v159, v40, v159
    v_mul_f32 v160, v40, v160
    v_mul_f32 v161, v40, v161
    v_mul_f32 v162, v40, v162
    v_mul_f32 v163, v40, v163
    v_mul_f32 v164, v40, v164
    v_mul_f32 v165, v40, v165
    v_mul_f32 v166, v40, v166
    v_mul_f32 v167, v40, v167
    v_mul_f32 v168, v40, v168
    v_mul_f32 v169, v40, v169
    v_mul_f32 v170, v40, v170
    v_mul_f32 v171, v40, v171
    v_mul_f32 v172, v40, v172
    v_mul_f32 v173, v40, v173
    v_mul_f32 v174, v40, v174
    v_mul_f32 v175, v40, v175
    v_mul_f32 v176, v40, v176
    v_mul_f32 v177, v40, v177
    v_mul_f32 v178, v40, v178
    v_mul_f32 v179, v40, v179
    v_mul_f32 v180, v40, v180
    v_mul_f32 v181, v40, v181
    v_mul_f32 v182, v40, v182
    v_mul_f32 v183, v40, v183
    v_mul_f32 v184, v40, v184
    v_mul_f32 v185, v40, v185
    v_mul_f32 v186, v40, v186
    v_mul_f32 v187, v40, v187
    v_cmp_gt_f32 vcc, v39, v36
    v_mov_b32 v37, v36
    v_mov_b32 v36, v39
    v_mov_b32 v38, 0x41000000
    v_mov_b32 v40, 0xff800000
    v_cndmask_b32 v38, v38, v40, vcc
    v_sub_f32 v8, 0, v36
    v_mov_b32 v9, v8
    v_mov_b32 v10, v8
    v_mov_b32 v11, v8
    v_mov_b32 v12, v8
    v_mov_b32 v13, v8
    v_mov_b32 v14, v8
    v_mov_b32 v15, v8
    v_mov_b32 v16, v8
    v_mov_b32 v17, v8
    v_mov_b32 v18, v8
    v_mov_b32 v19, v8
    v_mov_b32 v20, v8
    v_mov_b32 v21, v8
    v_mov_b32 v22, v8
    v_mov_b32 v23, v8
    s_nop 7
    s_branch L_resc_2_back
L_resc_3:
    s_nop 15
    v_mov_b32 v40, v39
    s_nop 1
    v_permlane32_swap_b32 v39, v40
    s_nop 1
    v_max_f32 v39, v39, v40
    v_add_f32 v39, v39, v37
    v_max_f32 v39, v39, v36
    v_sub_f32 v40, v36, v39
    v_exp_f32 v40, v40
    v_sub_f32 v38, v39, v37
    v_accvgpr_read_b32 v37, a36
    v_sub_f32 v44, v44, v38
    v_sub_f32 v45, v45, v38
    v_sub_f32 v46, v46, v38
    v_sub_f32 v47, v47, v38
    v_sub_f32 v48, v48, v38
    v_sub_f32 v49, v49, v38
    v_sub_f32 v50, v50, v38
    v_sub_f32 v51, v51, v38
    v_sub_f32 v52, v52, v38
    v_sub_f32 v53, v53, v38
    v_sub_f32 v54, v54, v38
    v_sub_f32 v55, v55, v38
    v_sub_f32 v56, v56, v38
    v_sub_f32 v57, v57, v38
    v_sub_f32 v58, v58, v38
    v_sub_f32 v59, v59, v38
    v_sub_f32 v60, v60, v38
    v_sub_f32 v61, v61, v38
    v_sub_f32 v62, v62, v38
    v_sub_f32 v63, v63, v38
    v_sub_f32 v64, v64, v38
    v_sub_f32 v65, v65, v38
    v_sub_f32 v66, v66, v38
    v_sub_f32 v67, v67, v38
    v_sub_f32 v68, v68, v38
    v_sub_f32 v69, v69, v38
    v_sub_f32 v70, v70, v38
    v_sub_f32 v71, v71, v38
    v_sub_f32 v72, v72, v38
    v_sub_f32 v73, v73, v38
    v_sub_f32 v74, v74, v38
    v_sub_f32 v75, v75, v38
    v_mul_f32 v37, v40, v37
    v_accvgpr_write_b32 a36, v37
    v_mul_f32 v124, v40, v124
    v_mul_f32 v125, v40, v125
    v_mul_f32 v126, v40, v126
    v_mul_f32 v127, v40, v127
    v_mul_f32 v128, v40, v128
    v_mul_f32 v129, v40, v129
    v_mul_f32 v130, v40, v130
    v_mul_f32 v131, v40, v131
    v_mul_f32 v132, v40, v132
    v_mul_f32 v133, v40, v133
    v_mul_f32 v134, v40, v134
    v_mul_f32 v135, v40, v135
    v_mul_f32 v136, v40, v136
    v_mul_f32 v137, v40, v137
    v_mul_f32 v138, v40, v138
    v_mul_f32 v139, v40, v139
    v_mul_f32 v140, v40, v140
    v_mul_f32 v141, v40, v141
    v_mul_f32 v142, v40, v142
    v_mul_f32 v143, v40, v143
    v_mul_f32 v144, v40, v144
    v_mul_f32 v145, v40, v145
    v_mul_f32 v146, v40, v146
    v_mul_f32 v147, v40, v147
    v_mul_f32 v148, v40, v148
    v_mul_f32 v149, v40, v149
    v_mul_f32 v150, v40, v150
    v_mul_f32 v151, v40, v151
    v_mul_f32 v152, v40, v152
    v_mul_f32 v153, v40, v153
    v_mul_f32 v154, v40, v154
    v_mul_f32 v155, v40, v155
    v_mul_f32 v156, v40, v156
    v_mul_f32 v157, v40, v157
    v_mul_f32 v158, v40, v158
    v_mul_f32 v159, v40, v159
    v_mul_f32 v160, v40, v160
    v_mul_f32 v161, v40, v161
    v_mul_f32 v162, v40, v162
    v_mul_f32 v163, v40, v163
    v_mul_f32 v164, v40, v164
    v_mul_f32 v165, v40, v165
    v_mul_f32 v166, v40, v166
    v_mul_f32 v167, v40, v167
    v_mul_f32 v168, v40, v168
    v_mul_f32 v169, v40, v169
    v_mul_f32 v170, v40, v170
    v_mul_f32 v171, v40, v171
    v_mul_f32 v172, v40, v172
    v_mul_f32 v173, v40, v173
    v_mul_f32 v174, v40, v174
    v_mul_f32 v175, v40, v175
    v_mul_f32 v176, v40, v176
    v_mul_f32 v177, v40, v177
    v_mul_f32 v178, v40, v178
    v_mul_f32 v179, v40, v179
    v_mul_f32 v180, v40, v180
    v_mul_f32 v181, v40, v181
    v_mul_f32 v182, v40, v182
    v_mul_f32 v183, v40, v183
    v_mul_f32 v184, v40, v184
    v_mul_f32 v185, v40, v185
    v_mul_f32 v186, v40, v186
    v_mul_f32 v187, v40, v187
    v_cmp_gt_f32 vcc, v39, v36
    v_mov_b32 v37, v36
    v_mov_b32 v36, v39
    v_mov_b32 v38, 0x41000000
    v_mov_b32 v40, 0xff800000
    v_cndmask_b32 v38, v38, v40, vcc
    v_sub_f32 v8, 0, v36
    v_mov_b32 v9, v8
    v_mov_b32 v10, v8
    v_mov_b32 v11, v8
    v_mov_b32 v12, v8
    v_mov_b32 v13, v8
    v_mov_b32 v14, v8
    v_mov_b32 v15, v8
    v_mov_b32 v16, v8
    v_mov_b32 v17, v8
    v_mov_b32 v18, v8
    v_mov_b32 v19, v8
    v_mov_b32 v20, v8
    v_mov_b32 v21, v8
    v_mov_b32 v22, v8
    v_mov_b32 v23, v8
    s_nop 7
    s_branch L_resc_3_back
L_resc_4:
    s_nop 15
    v_mov_b32 v40, v39
    s_nop 1
    v_permlane32_swap_b32 v39, v40
    s_nop 1
    v_max_f32 v39, v39, v40
    v_add_f32 v39, v39, v37
    v_max_f32 v39, v39, v36
    v_sub_f32 v40, v36, v39
    v_exp_f32 v40, v40
    v_sub_f32 v38, v39, v37
    v_accvgpr_read_b32 v37, a36
    v_sub_f32 v76, v76, v38
    v_sub_f32 v77, v77, v38
    v_sub_f32 v78, v78, v38
    v_sub_f32 v79, v79, v38
    v_sub_f32 v80, v80, v38
    v_sub_f32 v81, v81, v38
    v_sub_f32 v82, v82, v38
    v_sub_f32 v83, v83, v38
    v_sub_f32 v84, v84, v38
    v_sub_f32 v85, v85, v38
    v_sub_f32 v86, v86, v38
    v_sub_f32 v87, v87, v38
    v_sub_f32 v88, v88, v38
    v_sub_f32 v89, v89, v38
    v_sub_f32 v90, v90, v38
    v_sub_f32 v91, v91, v38
    v_sub_f32 v92, v92, v38
    v_sub_f32 v93, v93, v38
    v_sub_f32 v94, v94, v38
    v_sub_f32 v95, v95, v38
    v_sub_f32 v96, v96, v38
    v_sub_f32 v97, v97, v38
    v_sub_f32 v98, v98, v38
    v_sub_f32 v99, v99, v38
    v_sub_f32 v100, v100, v38
    v_sub_f32 v101, v101, v38
    v_sub_f32 v102, v102, v38
    v_sub_f32 v103, v103, v38
    v_sub_f32 v104, v104, v38
    v_sub_f32 v105, v105, v38
    v_sub_f32 v106, v106, v38
    v_sub_f32 v107, v107, v38
    v_mul_f32 v37, v40, v37
    v_accvgpr_write_b32 a36, v37
    v_mul_f32 v124, v40, v124
    v_mul_f32 v125, v40, v125
    v_mul_f32 v126, v40, v126
    v_mul_f32 v127, v40, v127
    v_mul_f32 v128, v40, v128
    v_mul_f32 v129, v40, v129
    v_mul_f32 v130, v40, v130
    v_mul_f32 v131, v40, v131
    v_mul_f32 v132, v40, v132
    v_mul_f32 v133, v40, v133
    v_mul_f32 v134, v40, v134
    v_mul_f32 v135, v40, v135
    v_mul_f32 v136, v40, v136
    v_mul_f32 v137, v40, v137
    v_mul_f32 v138, v40, v138
    v_mul_f32 v139, v40, v139
    v_mul_f32 v140, v40, v140
    v_mul_f32 v141, v40, v141
    v_mul_f32 v142, v40, v142
    v_mul_f32 v143, v40, v143
    v_mul_f32 v144, v40, v144
    v_mul_f32 v145, v40, v145
    v_mul_f32 v146, v40, v146
    v_mul_f32 v147, v40, v147
    v_mul_f32 v148, v40, v148
    v_mul_f32 v149, v40, v149
    v_mul_f32 v150, v40, v150
    v_mul_f32 v151, v40, v151
    v_mul_f32 v152, v40, v152
    v_mul_f32 v153, v40, v153
    v_mul_f32 v154, v40, v154
    v_mul_f32 v155, v40, v155
    v_mul_f32 v156, v40, v156
    v_mul_f32 v157, v40, v157
    v_mul_f32 v158, v40, v158
    v_mul_f32 v159, v40, v159
    v_mul_f32 v160, v40, v160
    v_mul_f32 v161, v40, v161
    v_mul_f32 v162, v40, v162
    v_mul_f32 v163, v40, v163
    v_mul_f32 v164, v40, v164
    v_mul_f32 v165, v40, v165
    v_mul_f32 v166, v40, v166
    v_mul_f32 v167, v40, v167
    v_mul_f32 v168, v40, v168
    v_mul_f32 v169, v40, v169
    v_mul_f32 v170, v40, v170
    v_mul_f32 v171, v40, v171
    v_mul_f32 v172, v40, v172
    v_mul_f32 v173, v40, v173
    v_mul_f32 v174, v40, v174
    v_mul_f32 v175, v40, v175
    v_mul_f32 v176, v40, v176
    v_mul_f32 v177, v40, v177
    v_mul_f32 v178, v40, v178
    v_mul_f32 v179, v40, v179
    v_mul_f32 v180, v40, v180
    v_mul_f32 v181, v40, v181
    v_mul_f32 v182, v40, v182
    v_mul_f32 v183, v40, v183
    v_mul_f32 v184, v40, v184
    v_mul_f32 v185, v40, v185
    v_mul_f32 v186, v40, v186
    v_mul_f32 v187, v40, v187
    v_cmp_gt_f32 vcc, v39, v36
    v_mov_b32 v37, v36
    v_mov_b32 v36, v39
    v_mov_b32 v38, 0x41000000
    v_mov_b32 v40, 0xff800000
    v_cndmask_b32 v38, v38, v40, vcc
    v_sub_f32 v8, 0, v36
    v_mov_b32 v9, v8
    v_mov_b32 v10, v8
    v_mov_b32 v11, v8
    v_mov_b32 v12, v8
    v_mov_b32 v13, v8
    v_mov_b32 v14, v8
    v_mov_b32 v15, v8
    v_mov_b32 v16, v8
    v_mov_b32 v17, v8
    v_mov_b32 v18, v8
    v_mov_b32 v19, v8
    v_mov_b32 v20, v8
    v_mov_b32 v21, v8
    v_mov_b32 v22, v8
    v_mov_b32 v23, v8
    s_nop 7
    s_branch L_resc_4_back
L_resc_5:
    s_nop 15
    v_mov_b32 v40, v39
    s_nop 1
    v_permlane32_swap_b32 v39, v40
    s_nop 1
    v_max_f32 v39, v39, v40
    v_add_f32 v39, v39, v37
    v_max_f32 v39, v39, v36
    v_sub_f32 v40, v36, v39
    v_exp_f32 v40, v40
    v_sub_f32 v38, v39, v37
    v_accvgpr_read_b32 v37, a36
    v_sub_f32 v44, v44, v38
    v_sub_f32 v45, v45, v38
    v_sub_f32 v46, v46, v38
    v_sub_f32 v47, v47, v38
    v_sub_f32 v48, v48, v38
    v_sub_f32 v49, v49, v38
    v_sub_f32 v50, v50, v38
    v_sub_f32 v51, v51, v38
    v_sub_f32 v52, v52, v38
    v_sub_f32 v53, v53, v38
    v_sub_f32 v54, v54, v38
    v_sub_f32 v55, v55, v38
    v_sub_f32 v56, v56, v38
    v_sub_f32 v57, v57, v38
    v_sub_f32 v58, v58, v38
    v_sub_f32 v59, v59, v38
    v_sub_f32 v60, v60, v38
    v_sub_f32 v61, v61, v38
    v_sub_f32 v62, v62, v38
    v_sub_f32 v63, v63, v38
    v_sub_f32 v64, v64, v38
    v_sub_f32 v65, v65, v38
    v_sub_f32 v66, v66, v38
    v_sub_f32 v67, v67, v38
    v_sub_f32 v68, v68, v38
    v_sub_f32 v69, v69, v38
    v_sub_f32 v70, v70, v38
    v_sub_f32 v71, v71, v38
    v_sub_f32 v72, v72, v38
    v_sub_f32 v73, v73, v38
    v_sub_f32 v74, v74, v38
    v_sub_f32 v75, v75, v38
    v_mul_f32 v37, v40, v37
    v_accvgpr_write_b32 a36, v37
    v_mul_f32 v124, v40, v124
    v_mul_f32 v125, v40, v125
    v_mul_f32 v126, v40, v126
    v_mul_f32 v127, v40, v127
    v_mul_f32 v128, v40, v128
    v_mul_f32 v129, v40, v129
    v_mul_f32 v130, v40, v130
    v_mul_f32 v131, v40, v131
    v_mul_f32 v132, v40, v132
    v_mul_f32 v133, v40, v133
    v_mul_f32 v134, v40, v134
    v_mul_f32 v135, v40, v135
    v_mul_f32 v136, v40, v136
    v_mul_f32 v137, v40, v137
    v_mul_f32 v138, v40, v138
    v_mul_f32 v139, v40, v139
    v_mul_f32 v140, v40, v140
    v_mul_f32 v141, v40, v141
    v_mul_f32 v142, v40, v142
    v_mul_f32 v143, v40, v143
    v_mul_f32 v144, v40, v144
    v_mul_f32 v145, v40, v145
    v_mul_f32 v146, v40, v146
    v_mul_f32 v147, v40, v147
    v_mul_f32 v148, v40, v148
    v_mul_f32 v149, v40, v149
    v_mul_f32 v150, v40, v150
    v_mul_f32 v151, v40, v151
    v_mul_f32 v152, v40, v152
    v_mul_f32 v153, v40, v153
    v_mul_f32 v154, v40, v154
    v_mul_f32 v155, v40, v155
    v_mul_f32 v156, v40, v156
    v_mul_f32 v157, v40, v157
    v_mul_f32 v158, v40, v158
    v_mul_f32 v159, v40, v159
    v_mul_f32 v160, v40, v160
    v_mul_f32 v161, v40, v161
    v_mul_f32 v162, v40, v162
    v_mul_f32 v163, v40, v163
    v_mul_f32 v164, v40, v164
    v_mul_f32 v165, v40, v165
    v_mul_f32 v166, v40, v166
    v_mul_f32 v167, v40, v167
    v_mul_f32 v168, v40, v168
    v_mul_f32 v169, v40, v169
    v_mul_f32 v170, v40, v170
    v_mul_f32 v171, v40, v171
    v_mul_f32 v172, v40, v172
    v_mul_f32 v173, v40, v173
    v_mul_f32 v174, v40, v174
    v_mul_f32 v175, v40, v175
    v_mul_f32 v176, v40, v176
    v_mul_f32 v177, v40, v177
    v_mul_f32 v178, v40, v178
    v_mul_f32 v179, v40, v179
    v_mul_f32 v180, v40, v180
    v_mul_f32 v181, v40, v181
    v_mul_f32 v182, v40, v182
    v_mul_f32 v183, v40, v183
    v_mul_f32 v184, v40, v184
    v_mul_f32 v185, v40, v185
    v_mul_f32 v186, v40, v186
    v_mul_f32 v187, v40, v187
    v_cmp_gt_f32 vcc, v39, v36
    v_mov_b32 v37, v36
    v_mov_b32 v36, v39
    v_mov_b32 v38, 0x41000000
    v_mov_b32 v40, 0xff800000
    v_cndmask_b32 v38, v38, v40, vcc
    v_sub_f32 v8, 0, v36
    v_mov_b32 v9, v8
    v_mov_b32 v10, v8
    v_mov_b32 v11, v8
    v_mov_b32 v12, v8
    v_mov_b32 v13, v8
    v_mov_b32 v14, v8
    v_mov_b32 v15, v8
    v_mov_b32 v16, v8
    v_mov_b32 v17, v8
    v_mov_b32 v18, v8
    v_mov_b32 v19, v8
    v_mov_b32 v20, v8
    v_mov_b32 v21, v8
    v_mov_b32 v22, v8
    v_mov_b32 v23, v8
    s_nop 7
    s_branch L_resc_5_back
L_resc_6:
    s_nop 15
    v_mov_b32 v40, v39
    s_nop 1
    v_permlane32_swap_b32 v39, v40
    s_nop 1
    v_max_f32 v39, v39, v40
    v_add_f32 v39, v39, v37
    v_max_f32 v39, v39, v36
    v_sub_f32 v40, v36, v39
    v_exp_f32 v40, v40
    v_sub_f32 v38, v39, v37
    v_accvgpr_read_b32 v37, a36
    v_sub_f32 v76, v76, v38
    v_sub_f32 v77, v77, v38
    v_sub_f32 v78, v78, v38
    v_sub_f32 v79, v79, v38
    v_sub_f32 v80, v80, v38
    v_sub_f32 v81, v81, v38
    v_sub_f32 v82, v82, v38
    v_sub_f32 v83, v83, v38
    v_sub_f32 v84, v84, v38
    v_sub_f32 v85, v85, v38
    v_sub_f32 v86, v86, v38
    v_sub_f32 v87, v87, v38
    v_sub_f32 v88, v88, v38
    v_sub_f32 v89, v89, v38
    v_sub_f32 v90, v90, v38
    v_sub_f32 v91, v91, v38
    v_sub_f32 v92, v92, v38
    v_sub_f32 v93, v93, v38
    v_sub_f32 v94, v94, v38
    v_sub_f32 v95, v95, v38
    v_sub_f32 v96, v96, v38
    v_sub_f32 v97, v97, v38
    v_sub_f32 v98, v98, v38
    v_sub_f32 v99, v99, v38
    v_sub_f32 v100, v100, v38
    v_sub_f32 v101, v101, v38
    v_sub_f32 v102, v102, v38
    v_sub_f32 v103, v103, v38
    v_sub_f32 v104, v104, v38
    v_sub_f32 v105, v105, v38
    v_sub_f32 v106, v106, v38
    v_sub_f32 v107, v107, v38
    v_mul_f32 v37, v40, v37
    v_accvgpr_write_b32 a36, v37
    v_mul_f32 v124, v40, v124
    v_mul_f32 v125, v40, v125
    v_mul_f32 v126, v40, v126
    v_mul_f32 v127, v40, v127
    v_mul_f32 v128, v40, v128
    v_mul_f32 v129, v40, v129
    v_mul_f32 v130, v40, v130
    v_mul_f32 v131, v40, v131
    v_mul_f32 v132, v40, v132
    v_mul_f32 v133, v40, v133
    v_mul_f32 v134, v40, v134
    v_mul_f32 v135, v40, v135
    v_mul_f32 v136, v40, v136
    v_mul_f32 v137, v40, v137
    v_mul_f32 v138, v40, v138
    v_mul_f32 v139, v40, v139
    v_mul_f32 v140, v40, v140
    v_mul_f32 v141, v40, v141
    v_mul_f32 v142, v40, v142
    v_mul_f32 v143, v40, v143
    v_mul_f32 v144, v40, v144
    v_mul_f32 v145, v40, v145
    v_mul_f32 v146, v40, v146
    v_mul_f32 v147, v40, v147
    v_mul_f32 v148, v40, v148
    v_mul_f32 v149, v40, v149
    v_mul_f32 v150, v40, v150
    v_mul_f32 v151, v40, v151
    v_mul_f32 v152, v40, v152
    v_mul_f32 v153, v40, v153
    v_mul_f32 v154, v40, v154
    v_mul_f32 v155, v40, v155
    v_mul_f32 v156, v40, v156
    v_mul_f32 v157, v40, v157
    v_mul_f32 v158, v40, v158
    v_mul_f32 v159, v40, v159
    v_mul_f32 v160, v40, v160
    v_mul_f32 v161, v40, v161
    v_mul_f32 v162, v40, v162
    v_mul_f32 v163, v40, v163
    v_mul_f32 v164, v40, v164
    v_mul_f32 v165, v40, v165
    v_mul_f32 v166, v40, v166
    v_mul_f32 v167, v40, v167
    v_mul_f32 v168, v40, v168
    v_mul_f32 v169, v40, v169
    v_mul_f32 v170, v40, v170
    v_mul_f32 v171, v40, v171
    v_mul_f32 v172, v40, v172
    v_mul_f32 v173, v40, v173
    v_mul_f32 v174, v40, v174
    v_mul_f32 v175, v40, v175
    v_mul_f32 v176, v40, v176
    v_mul_f32 v177, v40, v177
    v_mul_f32 v178, v40, v178
    v_mul_f32 v179, v40, v179
    v_mul_f32 v180, v40, v180
    v_mul_f32 v181, v40, v181
    v_mul_f32 v182, v40, v182
    v_mul_f32 v183, v40, v183
    v_mul_f32 v184, v40, v184
    v_mul_f32 v185, v40, v185
    v_mul_f32 v186, v40, v186
    v_mul_f32 v187, v40, v187
    v_cmp_gt_f32 vcc, v39, v36
    v_mov_b32 v37, v36
    v_mov_b32 v36, v39
    v_mov_b32 v38, 0x41000000
    v_mov_b32 v40, 0xff800000
    v_cndmask_b32 v38, v38, v40, vcc
    v_sub_f32 v8, 0, v36
    v_mov_b32 v9, v8
    v_mov_b32 v10, v8
    v_mov_b32 v11, v8
    v_mov_b32 v12, v8
    v_mov_b32 v13, v8
    v_mov_b32 v14, v8
    v_mov_b32 v15, v8
    v_mov_b32 v16, v8
    v_mov_b32 v17, v8
    v_mov_b32 v18, v8
    v_mov_b32 v19, v8
    v_mov_b32 v20, v8
    v_mov_b32 v21, v8
    v_mov_b32 v22, v8
    v_mov_b32 v23, v8
    s_nop 7
    s_branch L_resc_6_back
L_resc_7:
    s_nop 15
    v_mov_b32 v40, v39
    s_nop 1
    v_permlane32_swap_b32 v39, v40
    s_nop 1
    v_max_f32 v39, v39, v40
    v_add_f32 v39, v39, v37
    v_max_f32 v39, v39, v36
    v_sub_f32 v40, v36, v39
    v_exp_f32 v40, v40
    v_sub_f32 v38, v39, v37
    v_accvgpr_read_b32 v37, a36
    v_sub_f32 v44, v44, v38
    v_sub_f32 v45, v45, v38
    v_sub_f32 v46, v46, v38
    v_sub_f32 v47, v47, v38
    v_sub_f32 v48, v48, v38
    v_sub_f32 v49, v49, v38
    v_sub_f32 v50, v50, v38
    v_sub_f32 v51, v51, v38
    v_sub_f32 v52, v52, v38
    v_sub_f32 v53, v53, v38
    v_sub_f32 v54, v54, v38
    v_sub_f32 v55, v55, v38
    v_sub_f32 v56, v56, v38
    v_sub_f32 v57, v57, v38
    v_sub_f32 v58, v58, v38
    v_sub_f32 v59, v59, v38
    v_sub_f32 v60, v60, v38
    v_sub_f32 v61, v61, v38
    v_sub_f32 v62, v62, v38
    v_sub_f32 v63, v63, v38
    v_sub_f32 v64, v64, v38
    v_sub_f32 v65, v65, v38
    v_sub_f32 v66, v66, v38
    v_sub_f32 v67, v67, v38
    v_sub_f32 v68, v68, v38
    v_sub_f32 v69, v69, v38
    v_sub_f32 v70, v70, v38
    v_sub_f32 v71, v71, v38
    v_sub_f32 v72, v72, v38
    v_sub_f32 v73, v73, v38
    v_sub_f32 v74, v74, v38
    v_sub_f32 v75, v75, v38
    v_mul_f32 v37, v40, v37
    v_accvgpr_write_b32 a36, v37
    v_mul_f32 v124, v40, v124
    v_mul_f32 v125, v40, v125
    v_mul_f32 v126, v40, v126
    v_mul_f32 v127, v40, v127
    v_mul_f32 v128, v40, v128
    v_mul_f32 v129, v40, v129
    v_mul_f32 v130, v40, v130
    v_mul_f32 v131, v40, v131
    v_mul_f32 v132, v40, v132
    v_mul_f32 v133, v40, v133
    v_mul_f32 v134, v40, v134
    v_mul_f32 v135, v40, v135
    v_mul_f32 v136, v40, v136
    v_mul_f32 v137, v40, v137
    v_mul_f32 v138, v40, v138
    v_mul_f32 v139, v40, v139
    v_mul_f32 v140, v40, v140
    v_mul_f32 v141, v40, v141
    v_mul_f32 v142, v40, v142
    v_mul_f32 v143, v40, v143
    v_mul_f32 v144, v40, v144
    v_mul_f32 v145, v40, v145
    v_mul_f32 v146, v40, v146
    v_mul_f32 v147, v40, v147
    v_mul_f32 v148, v40, v148
    v_mul_f32 v149, v40, v149
    v_mul_f32 v150, v40, v150
    v_mul_f32 v151, v40, v151
    v_mul_f32 v152, v40, v152
    v_mul_f32 v153, v40, v153
    v_mul_f32 v154, v40, v154
    v_mul_f32 v155, v40, v155
    v_mul_f32 v156, v40, v156
    v_mul_f32 v157, v40, v157
    v_mul_f32 v158, v40, v158
    v_mul_f32 v159, v40, v159
    v_mul_f32 v160, v40, v160
    v_mul_f32 v161, v40, v161
    v_mul_f32 v162, v40, v162
    v_mul_f32 v163, v40, v163
    v_mul_f32 v164, v40, v164
    v_mul_f32 v165, v40, v165
    v_mul_f32 v166, v40, v166
    v_mul_f32 v167, v40, v167
    v_mul_f32 v168, v40, v168
    v_mul_f32 v169, v40, v169
    v_mul_f32 v170, v40, v170
    v_mul_f32 v171, v40, v171
    v_mul_f32 v172, v40, v172
    v_mul_f32 v173, v40, v173
    v_mul_f32 v174, v40, v174
    v_mul_f32 v175, v40, v175
    v_mul_f32 v176, v40, v176
    v_mul_f32 v177, v40, v177
    v_mul_f32 v178, v40, v178
    v_mul_f32 v179, v40, v179
    v_mul_f32 v180, v40, v180
    v_mul_f32 v181, v40, v181
    v_mul_f32 v182, v40, v182
    v_mul_f32 v183, v40, v183
    v_mul_f32 v184, v40, v184
    v_mul_f32 v185, v40, v185
    v_mul_f32 v186, v40, v186
    v_mul_f32 v187, v40, v187
    v_cmp_gt_f32 vcc, v39, v36
    v_mov_b32 v37, v36
    v_mov_b32 v36, v39
    v_mov_b32 v38, 0x41000000
    v_mov_b32 v40, 0xff800000
    v_cndmask_b32 v38, v38, v40, vcc
    v_sub_f32 v8, 0, v36
    v_mov_b32 v9, v8
    v_mov_b32 v10, v8
    v_mov_b32 v11, v8
    v_mov_b32 v12, v8
    v_mov_b32 v13, v8
    v_mov_b32 v14, v8
    v_mov_b32 v15, v8
    v_mov_b32 v16, v8
    v_mov_b32 v17, v8
    v_mov_b32 v18, v8
    v_mov_b32 v19, v8
    v_mov_b32 v20, v8
    v_mov_b32 v21, v8
    v_mov_b32 v22, v8
    v_mov_b32 v23, v8
    s_nop 7
    s_branch L_resc_7_back
L_nspin:
    s_mov_b32 s76, 0
    s_waitcnt vmcnt(0) lgkmcnt(0)
L_nspin_loop:
    global_load_dword v41, v2, s[16:17] sc0 sc1
    s_waitcnt vmcnt(0)
    s_waitcnt vmcnt(0)
    v_readfirstlane_b32 s70, v41
    s_nop 3
    s_cmp_lg_u32 s70, 0
    s_cbranch_scc1 L_nspin_back
    s_add_u32 s76, s76, 1
    s_cmp_lt_u32 s76, 65536
    s_cbranch_scc1 L_nspin_loop
    s_branch L_nspin_back
L_own_slow:
    s_barrier
    v_add_u32 v32, 16384, v32
    v_add_u32 v33, 16384, v33
    v_add_u32 v34, 16384, v34
    v_add_u32 v35, 16384, v35
    ds_read_b64_tr_b16 a[52:53], v32 offset:0
    ds_read_b64_tr_b16 a[54:55], v32 offset:2048
    ds_read_b64_tr_b16 a[56:57], v32 offset:4096
    ds_read_b64_tr_b16 a[58:59], v32 offset:6144
    ds_read_b64_tr_b16 a[60:61], v32 offset:8192
    ds_read_b64_tr_b16 a[62:63], v32 offset:10240
    ds_read_b64_tr_b16 a[64:65], v32 offset:12288
    ds_read_b64_tr_b16 a[66:67], v32 offset:14336
    s_waitcnt lgkmcnt(4)
    v_mfma_f32_32x32x16_bf16 v[124:139], a[52:55], v[108:111], v[124:139]
    ds_read_b64_tr_b16 a[52:53], v33 offset:0
    ds_read_b64_tr_b16 a[54:55], v33 offset:2048
    v_mfma_f32_32x32x16_bf16 v[124:139], a[56:59], v[112:115], v[124:139]
    ds_read_b64_tr_b16 a[56:57], v33 offset:4096
    ds_read_b64_tr_b16 a[58:59], v33 offset:6144
    s_waitcnt lgkmcnt(4)
    v_mfma_f32_32x32x16_bf16 v[124:139], a[60:63], v[116:119], v[124:139]
    ds_read_b64_tr_b16 a[60:61], v33 offset:8192
    ds_read_b64_tr_b16 a[62:63], v33 offset:10240
    v_mfma_f32_32x32x16_bf16 v[124:139], a[64:67], v[120:123], v[124:139]
    ds_read_b64_tr_b16 a[64:65], v33 offset:12288
    ds_read_b64_tr_b16 a[66:67], v33 offset:14336
    s_waitcnt lgkmcnt(4)
    v_mfma_f32_32x32x16_bf16 v[140:155], a[52:55], v[108:111], v[140:155]
    ds_read_b64_tr_b16 a[52:53], v34 offset:0
    ds_read_b64_tr_b16 a[54:55], v34 offset:2048
    v_mfma_f32_32x32x16_bf16 v[140:155], a[56:59], v[112:115], v[140:155]
    s_nop 4
    v_mul_f32 v124, v124, v42
    v_mul_f32 v125, v125, v42
    v_mul_f32 v126, v126, v42
    v_mul_f32 v127, v127, v42
    v_mul_f32 v128, v128, v42
    v_mul_f32 v129, v129, v42
    v_mul_f32 v130, v130, v42
    ds_read_b64_tr_b16 a[56:57], v34 offset:4096
    ds_read_b64_tr_b16 a[58:59], v34 offset:6144
    s_waitcnt lgkmcnt(4)
    v_mfma_f32_32x32x16_bf16 v[140:155], a[60:63], v[116:119], v[140:155]
    v_mul_f32 v131, v131, v42
    v_cvt_pk_bf16_f32 v76, v124, v125
    v_cvt_pk_bf16_f32 v77, v126, v127
    v_cvt_pk_bf16_f32 v78, v128, v129
    v_cvt_pk_bf16_f32 v79, v130, v131
    buffer_store_dwordx4 v[76:79], v4, s[48:51], s65 offen offset:0 sc1
    ds_read_b64_tr_b16 a[60:61], v34 offset:8192
    ds_read_b64_tr_b16 a[62:63], v34 offset:10240
    v_mfma_f32_32x32x16_bf16 v[140:155], a[64:67], v[120:123], v[140:155]
    v_mul_f32 v132, v132, v42
    v_mul_f32 v133, v133, v42
    v_mul_f32 v134, v134, v42
    v_mul_f32 v135, v135, v42
    v_mul_f32 v136, v136, v42
    v_mul_f32 v137, v137, v42
    v_mul_f32 v138, v138, v42
    ds_read_b64_tr_b16 a[64:65], v34 offset:12288
    ds_read_b64_tr_b16 a[66:67], v34 offset:14336
    s_waitcnt lgkmcnt(4)
    v_mfma_f32_32x32x16_bf16 v[156:171], a[52:55], v[108:111], v[156:171]
    v_mul_f32 v139, v139, v42
    v_cvt_pk_bf16_f32 v80, v132, v133
    v_cvt_pk_bf16_f32 v81, v134, v135
    v_cvt_pk_bf16_f32 v82, v136, v137
    v_cvt_pk_bf16_f32 v83, v138, v139
    buffer_store_dwordx4 v[80:83], v4, s[48:51], s65 offen offset:1024 sc1
    ds_read_b64_tr_b16 a[52:53], v35 offset:0
    ds_read_b64_tr_b16 a[54:55], v35 offset:2048
    v_mfma_f32_32x32x16_bf16 v[156:171], a[56:59], v[112:115], v[156:171]
    v_mul_f32 v140, v140, v42
    v_mul_f32 v141, v141, v42
    v_mul_f32 v142, v142, v42
    v_mul_f32 v143, v143, v42
    v_mul_f32 v144, v144, v42
    v_mul_f32 v145, v145, v42
    v_mul_f32 v146, v146, v42
    ds_read_b64_tr_b16 a[56:57], v35 offset:4096
    ds_read_b64_tr_b16 a[58:59], v35 offset:6144
    s_waitcnt lgkmcnt(4)
    v_mfma_f32_32x32x16_bf16 v[156:171], a[60:63], v[116:119], v[156:171]
    v_mul_f32 v147, v147, v42
    v_cvt_pk_bf16_f32 v84, v140, v141
    v_cvt_pk_bf16_f32 v85, v142, v143
    v_cvt_pk_bf16_f32 v86, v144, v145
    v_cvt_pk_bf16_f32 v87, v146, v147
    buffer_store_dwordx4 v[84:87], v4, s[48:51], s65 offen offset:2048 sc1
    ds_read_b64_tr_b16 a[60:61], v35 offset:8192
    ds_read_b64_tr_b16 a[62:63], v35 offset:10240
    v_mfma_f32_32x32x16_bf16 v[156:171], a[64:67], v[120:123], v[156:171]
    v_mul_f32 v148, v148, v42
    v_mul_f32 v149, v149, v42
    v_mul_f32 v150, v150, v42
    v_mul_f32 v151, v151, v42
    v_mul_f32 v152, v152, v42
    v_mul_f32 v153, v153, v42
    v_mul_f32 v154, v154, v42
    ds_read_b64_tr_b16 a[64:65], v35 offset:12288
    ds_read_b64_tr_b16 a[66:67], v35 offset:14336
    s_waitcnt lgkmcnt(4)
    v_mfma_f32_32x32x16_bf16 v[172:187], a[52:55], v[108:111], v[172:187]
    v_mul_f32 v155, v155, v42
    v_cvt_pk_bf16_f32 v88, v148, v149
    v_cvt_pk_bf16_f32 v89, v150, v151
    v_cvt_pk_bf16_f32 v90, v152, v153
    v_cvt_pk_bf16_f32 v91, v154, v155
    buffer_store_dwordx4 v[88:91], v4, s[48:51], s65 offen offset:3072 sc1
    v_mfma_f32_32x32x16_bf16 v[172:187], a[56:59], v[112:115], v[172:187]
    v_mul_f32 v156, v156, v42
    v_mul_f32 v157, v157, v42
    v_mul_f32 v158, v158, v42
    v_mul_f32 v159, v159, v42
    v_mul_f32 v160, v160, v42
    v_mul_f32 v161, v161, v42
    v_mul_f32 v162, v162, v42
    v_mul_f32 v163, v163, v42
    v_cvt_pk_bf16_f32 v92, v156, v157
    v_cvt_pk_bf16_f32 v93, v158, v159
    v_cvt_pk_bf16_f32 v94, v160, v161
    v_cvt_pk_bf16_f32 v95, v162, v163
    buffer_store_dwordx4 v[92:95], v4, s[48:51], s66 offen offset:0 sc1
    s_waitcnt lgkmcnt(0)
    v_mfma_f32_32x32x16_bf16 v[172:187], a[60:63], v[116:119], v[172:187]
    v_mul_f32 v164, v164, v42
    v_mul_f32 v165, v165, v42
    v_mul_f32 v166, v166, v42
    v_mul_f32 v167, v167, v42
    v_mul_f32 v168, v168, v42
    v_mul_f32 v169, v169, v42
    v_mul_f32 v170, v170, v42
    v_mul_f32 v171, v171, v42
    v_cvt_pk_bf16_f32 v96, v164, v165
    v_cvt_pk_bf16_f32 v97, v166, v167
    v_cvt_pk_bf16_f32 v98, v168, v169
    v_cvt_pk_bf16_f32 v99, v170, v171
    buffer_store_dwordx4 v[96:99], v4, s[48:51], s66 offen offset:1024 sc1
    v_mfma_f32_32x32x16_bf16 v[172:187], a[64:67], v[120:123], v[172:187]
    v_lshrrev_b32 v0, 5, v1
    v_mul_u32_u24 v0, 1152, v0
    v_and_b32 v41, 1, v1
    v_lshlrev_b32 v41, 3, v41
    v_add_u32 v0, v0, v41
    v_bfe_u32 v41, v1, 1, 1
    v_lshlrev_b32 v41, 4, v41
    v_add_u32 v0, v0, v41
    v_bfe_u32 v41, v1, 2, 2
    v_lshlrev_b32 v3, 5, v41
    v_add_u32 v36, v0, v3
    v_add_u32 v36, 1024, v36
    v_lshlrev_b32 v3, 8, v41
    v_add_u32 v0, v0, v3
    v_bfe_u32 v3, v1, 4, 1
    v_lshlrev_b32 v3, 5, v3
    v_add_u32 v0, v0, v3
    v_xor_b32 v3, 0, v41
    v_lshlrev_b32 v3, 6, v3
    v_add_u32 v32, v0, v3
    v_xor_b32 v3, 1, v41
    v_lshlrev_b32 v3, 6, v3
    v_add_u32 v33, v0, v3
    v_xor_b32 v3, 2, v41
    v_lshlrev_b32 v3, 6, v3
    v_add_u32 v34, v0, v3
    v_xor_b32 v3, 3, v41
    v_lshlrev_b32 v3, 6, v3
    v_add_u32 v35, v0, v3
    v_pk_mul_f32 v[172:173], v[172:173], v[42:43]
    v_pk_mul_f32 v[174:175], v[174:175], v[42:43]
    v_pk_mul_f32 v[176:177], v[176:177], v[42:43]
    v_pk_mul_f32 v[178:179], v[178:179], v[42:43]
    v_pk_mul_f32 v[180:181], v[180:181], v[42:43]
    v_pk_mul_f32 v[182:183], v[182:183], v[42:43]
    v_pk_mul_f32 v[184:185], v[184:185], v[42:43]
    v_pk_mul_f32 v[186:187], v[186:187], v[42:43]
    v_cvt_pk_bf16_f32 v100, v172, v173
    v_cvt_pk_bf16_f32 v101, v174, v175
    v_cvt_pk_bf16_f32 v102, v176, v177
    v_cvt_pk_bf16_f32 v103, v178, v179
    buffer_store_dwordx4 v[100:103], v4, s[48:51], s66 offen offset:2048 sc1
    v_cvt_pk_bf16_f32 v104, v180, v181
    v_cvt_pk_bf16_f32 v105, v182, v183
    v_cvt_pk_bf16_f32 v106, v184, v185
    v_cvt_pk_bf16_f32 v107, v186, v187
    buffer_store_dwordx4 v[104:107], v4, s[48:51], s66 offen offset:3072 sc1
    ds_read_b64_tr_b16 v[172:173], v32 offset:0
    ds_read_b64_tr_b16 v[174:175], v32 offset:2304
    ds_read_b64_tr_b16 v[176:177], v33 offset:0
    ds_read_b64_tr_b16 v[178:179], v33 offset:2304
    ds_read_b64_tr_b16 v[180:181], v34 offset:0
    ds_read_b64_tr_b16 v[182:183], v34 offset:2304
    ds_read_b64_tr_b16 v[184:185], v35 offset:0
    ds_read_b64_tr_b16 v[186:187], v35 offset:2304
    s_waitcnt lgkmcnt(4)
    v_mfma_f32_32x32x16_bf16 v[44:59], v[172:175], v[76:79], 0
    v_bfe_u32 v24, v1, 4, 1
    v_mul_u32_u24 v24, 36864, v24
    ds_read_b64_tr_b16 v[172:173], v36 offset:0
    ds_read_b64_tr_b16 v[174:175], v36 offset:2304
    v_mfma_f32_32x32x16_bf16 v[60:75], v[176:179], v[76:79], 0
    v_lshrrev_b32 v25, 5, v1
    v_lshlrev_b32 v25, 8, v25
    ds_read_b64_tr_b16 v[176:177], v32 offset:4608
    ds_read_b64_tr_b16 v[178:179], v32 offset:6912
    s_waitcnt lgkmcnt(4)
    v_mfma_f32_32x32x16_bf16 v[108:123], v[180:183], v[76:79], 0
    v_add_u32 v24, v24, v25
    ds_read_b64_tr_b16 v[180:181], v33 offset:4608
    ds_read_b64_tr_b16 v[182:183], v33 offset:6912
    v_mfma_f32_32x32x16_bf16 v[124:139], v[184:187], v[76:79], 0
    v_and_b32 v25, 15, v1
    v_lshlrev_b32 v26, 4, v25
    ds_read_b64_tr_b16 v[184:185], v34 offset:4608
    ds_read_b64_tr_b16 v[186:187], v34 offset:6912
    s_waitcnt lgkmcnt(4)
    v_mfma_f32_32x32x16_bf16 v[8:23], v[172:175], v[76:79], 0
    v_add_u32 v24, v24, v26
    ds_read_b64_tr_b16 v[172:173], v35 offset:4608
    ds_read_b64_tr_b16 v[174:175], v35 offset:6912
    v_mfma_f32_32x32x16_bf16 v[44:59], v[176:179], v[80:83], v[44:59]
    v_mul_u32_u24 v25, 1152, v25
    v_bfe_u32 v42, v1, 4, 1
    ds_read_b64_tr_b16 v[176:177], v36 offset:4608
    ds_read_b64_tr_b16 v[178:179], v36 offset:6912
    s_waitcnt lgkmcnt(4)
    v_mfma_f32_32x32x16_bf16 v[60:75], v[180:183], v[80:83], v[60:75]
    v_lshlrev_b32 v42, 3, v42
    v_add_u32 v25, v25, v42
    ds_read_b64_tr_b16 v[180:181], v32 offset:9216
    ds_read_b64_tr_b16 v[182:183], v32 offset:11520
    v_mfma_f32_32x32x16_bf16 v[108:123], v[184:187], v[80:83], v[108:123]
    v_lshrrev_b32 v42, 5, v1
    ds_read_b64_tr_b16 v[184:185], v33 offset:9216
    ds_read_b64_tr_b16 v[186:187], v33 offset:11520
    s_waitcnt lgkmcnt(4)
    v_mfma_f32_32x32x16_bf16 v[124:139], v[172:175], v[80:83], v[124:139]
    v_lshlrev_b32 v0, 5, v42
    v_add_u32 v25, v25, v0
    ds_read_b64_tr_b16 v[172:173], v34 offset:9216
    ds_read_b64_tr_b16 v[174:175], v34 offset:11520
    v_mfma_f32_32x32x16_bf16 v[8:23], v[176:179], v[80:83], v[8:23]
    v_lshrrev_b32 v27, 3, v1
    ds_read_b64_tr_b16 v[176:177], v35 offset:9216
    ds_read_b64_tr_b16 v[178:179], v35 offset:11520
    s_waitcnt lgkmcnt(4)
    v_mfma_f32_32x32x16_bf16 v[44:59], v[180:183], v[84:87], v[44:59]
    v_mul_u32_u24 v27, 4608, v27
    v_bfe_u32 v42, v1, 2, 1
    ds_read_b64_tr_b16 v[180:181], v36 offset:9216
    ds_read_b64_tr_b16 v[182:183], v36 offset:11520
    v_mfma_f32_32x32x16_bf16 v[60:75], v[184:187], v[84:87], v[60:75]
    v_lshlrev_b32 v0, 8, v42
    v_add_u32 v27, v27, v0
    ds_read_b64_tr_b16 v[184:185], v32 offset:13824
    ds_read_b64_tr_b16 v[186:187], v32 offset:16128
    s_waitcnt lgkmcnt(4)
    v_mfma_f32_32x32x16_bf16 v[108:123], v[172:175], v[84:87], v[108:123]
    v_lshlrev_b32 v26, 3, v42
    ds_read_b64_tr_b16 v[172:173], v33 offset:13824
    ds_read_b64_tr_b16 v[174:175], v33 offset:16128
    v_mfma_f32_32x32x16_bf16 v[124:139], v[176:179], v[84:87], v[124:139]
    v_add_u32 v26, 256, v26
    v_and_b32 v42, 3, v1
    ds_read_b64_tr_b16 v[176:177], v34 offset:13824
    ds_read_b64_tr_b16 v[178:179], v34 offset:16128
    s_waitcnt lgkmcnt(4)
    v_mfma_f32_32x32x16_bf16 v[8:23], v[180:183], v[84:87], v[8:23]
    s_lshl_b32 s72, s20, 2
    ds_read_b64_tr_b16 v[180:181], v35 offset:13824
    ds_read_b64_tr_b16 v[182:183], v35 offset:16128
    v_mfma_f32_32x32x16_bf16 v[44:59], v[184:187], v[88:91], v[44:59]
    v_add_u32 v42, s72, v42
    v_lshlrev_b32 v0, 4, v42
    ds_read_b64_tr_b16 v[184:185], v36 offset:13824
    ds_read_b64_tr_b16 v[186:187], v36 offset:16128
    s_waitcnt lgkmcnt(4)
    v_mfma_f32_32x32x16_bf16 v[60:75], v[172:175], v[88:91], v[60:75]
    v_add_u32 v27, v27, v0
    s_waitcnt vmcnt(0)
    s_mov_b64 exec, 1
    global_store_dword v6, v7, s[18:19] sc1
    s_mov_b64 exec, -1
    global_load_dword v30, v5, s[18:19] sc1
    global_load_dword v31, v5, s[18:19] sc1
    global_load_dword v41, v5, s[18:19] sc1
    ds_read_b64_tr_b16 v[172:173], v32 offset:18432
    ds_read_b64_tr_b16 v[174:175], v32 offset:20736
    v_mfma_f32_32x32x16_bf16 v[108:123], v[176:179], v[88:91], v[108:123]
    v_mul_u32_u24 v42, 1152, v42
    v_add_u32 v26, v26, v42
    ds_read_b64_tr_b16 v[176:177], v33 offset:18432
    ds_read_b64_tr_b16 v[178:179], v33 offset:20736
    s_waitcnt lgkmcnt(4)
    v_mfma_f32_32x32x16_bf16 v[124:139], v[180:183], v[88:91], v[124:139]
    v_cmp_gt_u32 vcc, 8, v1
    v_mov_b32 v42, 2146435072
    ds_read_b64_tr_b16 v[180:181], v34 offset:18432
    ds_read_b64_tr_b16 v[182:183], v34 offset:20736
    v_mfma_f32_32x32x16_bf16 v[8:23], v[184:187], v[88:91], v[8:23]
    v_cndmask_b32 v26, v42, v26, vcc
    ds_read_b64_tr_b16 v[184:185], v35 offset:18432
    ds_read_b64_tr_b16 v[186:187], v35 offset:20736
    s_waitcnt lgkmcnt(4)
    v_mfma_f32_32x32x16_bf16 v[44:59], v[172:175], v[92:95], v[44:59]
    s_lshl_b32 s72, s23, 2
    s_add_u32 s72, s72, s22
    ds_read_b64_tr_b16 v[172:173], v36 offset:18432
    ds_read_b64_tr_b16 v[174:175], v36 offset:20736
    v_mfma_f32_32x32x16_bf16 v[60:75], v[176:179], v[92:95], v[60:75]
    s_lshl_b32 s72, s72, 9
    ds_read_b64_tr_b16 v[176:177], v32 offset:23040
    ds_read_b64_tr_b16 v[178:179], v32 offset:25344
    s_waitcnt lgkmcnt(4)
    v_mfma_f32_32x32x16_bf16 v[108:123], v[180:183], v[92:95], v[108:123]
    s_add_u32 s72, s72, 33619968
    s_lshl_b32 s73, s20, 7
    ds_read_b64_tr_b16 v[180:181], v33 offset:23040
    ds_read_b64_tr_b16 v[182:183], v33 offset:25344
    v_mfma_f32_32x32x16_bf16 v[124:139], v[184:187], v[92:95], v[124:139]
    s_add_u32 s73, s73, s72
    v_mov_b32 v28, s73
    ds_read_b64_tr_b16 v[184:185], v34 offset:23040
    ds_read_b64_tr_b16 v[186:187], v34 offset:25344
    s_waitcnt lgkmcnt(4)
    v_mfma_f32_32x32x16_bf16 v[8:23], v[172:175], v[92:95], v[8:23]
    s_lshl_b32 s73, s21, 2
    ds_read_b64_tr_b16 v[172:173], v35 offset:23040
    ds_read_b64_tr_b16 v[174:175], v35 offset:25344
    v_mfma_f32_32x32x16_bf16 v[44:59], v[176:179], v[96:99], v[44:59]
    v_add_u32 v28, s73, v28
    s_lshl_b32 s73, s21, 6
    ds_read_b64_tr_b16 v[176:177], v36 offset:23040
    ds_read_b64_tr_b16 v[178:179], v36 offset:25344
    s_waitcnt lgkmcnt(4)
    v_mfma_f32_32x32x16_bf16 v[60:75], v[180:183], v[96:99], v[60:75]
    s_add_u32 s73, s73, s72
    ds_read_b64_tr_b16 v[180:181], v32 offset:27648
    ds_read_b64_tr_b16 v[182:183], v32 offset:29952
    v_mfma_f32_32x32x16_bf16 v[108:123], v[184:187], v[96:99], v[108:123]
    v_and_b32 v29, 7, v1
    v_lshlrev_b32 v29, 2, v29
    ds_read_b64_tr_b16 v[184:185], v33 offset:27648
    ds_read_b64_tr_b16 v[186:187], v33 offset:29952
    s_waitcnt lgkmcnt(4)
    v_mfma_f32_32x32x16_bf16 v[124:139], v[172:175], v[96:99], v[124:139]
    v_add_u32 v29, s73, v29
    ds_read_b64_tr_b16 v[172:173], v34 offset:27648
    ds_read_b64_tr_b16 v[174:175], v34 offset:29952
    v_mfma_f32_32x32x16_bf16 v[8:23], v[176:179], v[96:99], v[8:23]
    ds_read_b64_tr_b16 v[176:177], v35 offset:27648
    ds_read_b64_tr_b16 v[178:179], v35 offset:29952
    s_waitcnt lgkmcnt(4)
    v_mfma_f32_32x32x16_bf16 v[44:59], v[180:183], v[100:103], v[44:59]
    s_waitcnt vmcnt(2)
    v_cmp_ne_u32 vcc, s70, v30
    s_nop 3
    s_cbranch_vccz L_f1backb
    s_mov_b32 s76, 0
    global_load_dword v30, v5, s[18:19] sc1
L_f1loopb:
    s_waitcnt vmcnt(2)
    v_cmp_ne_u32 vcc, s70, v31
    s_nop 4
    s_cbranch_vccz L_f1backb
    s_nop 0
    global_load_dword v31, v5, s[18:19] sc1
    s_waitcnt vmcnt(2)
    v_cmp_ne_u32 vcc, s70, v41
    s_nop 4
    s_cbranch_vccz L_f1backb
    s_nop 0
    global_load_dword v41, v5, s[18:19] sc1
    s_waitcnt vmcnt(2)
    v_cmp_ne_u32 vcc, s70, v30
    s_nop 4
    s_cbranch_vccz L_f1backb
    s_nop 0
    global_load_dword v30, v5, s[18:19] sc1
    s_add_u32 s76, s76, 1
    s_cmp_lt_u32 s76, 65536
    s_cbranch_scc1 L_f1loopb
L_f1backb:
    s_add_u32 s68, s22, 1
    s_and_b32 s68, s68, 3
    s_lshl_b32 s68, s68, 13
    s_add_u32 s67, s68, 4096
    buffer_load_dwordx4 a[0:3], v4, s[48:51], s68 offen offset:0 sc1
    buffer_load_dwordx4 a[4:7], v4, s[48:51], s68 offen offset:1024 sc1
    ds_read_b64_tr_b16 v[180:181], v36 offset:27648
    ds_read_b64_tr_b16 v[182:183], v36 offset:29952
    v_mfma_f32_32x32x16_bf16 v[60:75], v[184:187], v[100:103], v[60:75]
    buffer_load_dwordx4 a[8:11], v4, s[48:51], s68 offen offset:2048 sc1
    buffer_load_dwordx4 a[12:15], v4, s[48:51], s68 offen offset:3072 sc1
    ds_read_b64_tr_b16 v[184:185], v32 offset:32256
    ds_read_b64_tr_b16 v[186:187], v32 offset:34560
    s_waitcnt lgkmcnt(4)
    v_mfma_f32_32x32x16_bf16 v[108:123], v[172:175], v[100:103], v[108:123]
    buffer_load_dwordx4 a[16:19], v4, s[48:51], s67 offen offset:0 sc1
    buffer_load_dwordx4 a[20:23], v4, s[48:51], s67 offen offset:1024 sc1
    ds_read_b64_tr_b16 v[172:173], v33 offset:32256
    ds_read_b64_tr_b16 v[174:175], v33 offset:34560
    v_mfma_f32_32x32x16_bf16 v[124:139], v[176:179], v[100:103], v[124:139]
    buffer_load_dwordx4 a[24:27], v4, s[48:51], s67 offen offset:2048 sc1
    buffer_load_dwordx4 a[28:31], v4, s[48:51], s67 offen offset:3072 sc1
    ds_read_b64_tr_b16 v[176:177], v34 offset:32256
    ds_read_b64_tr_b16 v[178:179], v34 offset:34560
    s_waitcnt lgkmcnt(4)
    v_mfma_f32_32x32x16_bf16 v[8:23], v[180:183], v[100:103], v[8:23]
    s_add_u32 s68, s22, 2
    s_and_b32 s68, s68, 3
    s_lshl_b32 s68, s68, 13
    s_add_u32 s67, s68, 4096
    buffer_load_dwordx4 a[32:35], v4, s[48:51], s68 offen offset:0 sc1
    ds_read_b64_tr_b16 v[180:181], v35 offset:32256
    ds_read_b64_tr_b16 v[182:183], v35 offset:34560
    v_mfma_f32_32x32x16_bf16 v[44:59], v[184:187], v[104:107], v[44:59]
    buffer_load_dwordx4 a[36:39], v4, s[48:51], s68 offen offset:1024 sc1
    buffer_load_dwordx4 a[40:43], v4, s[48:51], s68 offen offset:2048 sc1
    ds_read_b64_tr_b16 v[184:185], v36 offset:32256
    ds_read_b64_tr_b16 v[186:187], v36 offset:34560
    s_waitcnt lgkmcnt(4)
    v_mfma_f32_32x32x16_bf16 v[60:75], v[172:175], v[104:107], v[60:75]
    buffer_load_dwordx4 a[44:47], v4, s[48:51], s68 offen offset:3072 sc1
    buffer_load_dwordx4 a[48:51], v4, s[48:51], s67 offen offset:0 sc1
    v_mfma_f32_32x32x16_bf16 v[108:123], v[176:179], v[104:107], v[108:123]
    buffer_load_dwordx4 a[52:55], v4, s[48:51], s67 offen offset:1024 sc1
    buffer_load_dwordx4 a[56:59], v4, s[48:51], s67 offen offset:2048 sc1
    s_waitcnt lgkmcnt(0)
    v_mfma_f32_32x32x16_bf16 v[124:139], v[180:183], v[104:107], v[124:139]
    buffer_load_dwordx4 a[60:63], v4, s[48:51], s67 offen offset:3072 sc1
    v_mfma_f32_32x32x16_bf16 v[8:23], v[184:187], v[104:107], v[8:23]
    s_nop 15
    s_branch L_own_done
.section .rodata,"a"
.p2align 6
.amdhsa_kernel standalone__mha_block_cached__near_ridge_kernel
  .amdhsa_next_free_vgpr 256
  .amdhsa_next_free_sgpr 102
  .amdhsa_accum_offset 188
  .amdhsa_group_segment_fixed_size 0
  .amdhsa_kernarg_size 64
  .amdhsa_user_sgpr_count 2
  .amdhsa_user_sgpr_kernarg_segment_ptr 1
  .amdhsa_system_sgpr_workgroup_id_x 1
.end_amdhsa_kernel
```
